```python
import torch

def _softmax(x, axis=-1):
    return torch.softmax(x, dim=axis)
def _gelu(x):
    return torch.nn.functional.gelu(x, approximate="tanh")
def _silu(x):
    return torch.nn.functional.silu(x)
def _sigmoid(x):
    return torch.sigmoid(x)
def _layernorm(x, axis=-1, eps=1e-5):
    m = x.mean(dim=axis, keepdim=True)
    v = x.var(dim=axis, keepdim=True, unbiased=False)
    return (x - m) / torch.sqrt(v + eps)
def _scatter_add(tgt, idx, src, axis=0):
    return tgt.clone().index_add_(axis, idx, src)
def _segment_sum(src, seg, n):
    out = torch.zeros((n,) + src.shape[1:], dtype=src.dtype)
    return out.index_add_(0, seg, src)
def _pad(x, pw):
    flat = tuple(v for pair in reversed(pw) for v in pair)
    return torch.nn.functional.pad(x, flat)

kernel_name = 'standalone__mha_softmax__near_ridge'

def setup_inputs():

    _w = (lambda a: (lambda t: t.to(torch.bfloat16) if t.is_floating_point() else t)(torch.as_tensor(a)))
    B, H, Sq, Sk, D = 16, 32, 288, 512, 128
    return {
        "q": _w((lambda *s: torch.randn(*s, dtype=torch.bfloat16) * 0.8)(B, H, Sq, D)),
        "k": _w((lambda *s: torch.randn(*s, dtype=torch.bfloat16) * 0.8)(B, H, Sk, D)),
        "v": _w((lambda *s: torch.randn(*s, dtype=torch.bfloat16) * 0.05)(B, H, Sk, D)),
    }

def reference(q, k, v):
    scale = q.shape[-1] ** -0.5
    scores = torch.einsum("bhqd,bhkd->bhqk", q, k) * scale
    p = _softmax(scores, axis=-1)
    return torch.einsum("bhqk,bhkd->bhqd", p, v)
```

```asm
; @launch grid=(256,1,1) block=(256,1,1) lds=163264
.amdgcn_target "amdgcn-amd-amdhsa--gfx950"
.text
.globl standalone__mha_softmax__near_ridge_kernel
.p2align 12
.p2align 8
.type standalone__mha_softmax__near_ridge_kernel,@function
standalone__mha_softmax__near_ridge_kernel:
    s_cmp_ge_u32 s2, 256
    s_cbranch_scc1 L_end
    s_load_dwordx4 s[4:7], s[0:1], 0
    s_load_dwordx4 s[8:11], s[0:1], 16
    s_getpc_b64 s[62:63]
    s_and_b32 s62, s62, 0xfffff000
    s_lshl_b32 s61, s2, 12
    s_and_b32 s61, s61, 0x8000
    v_lshl_add_u32 v224, v0, 7, s61
    v_min_u32 v224, 49024, v224
    v_mov_b32 v225, s63
    v_add_co_u32 v224, vcc, s62, v224
    v_addc_co_u32 v225, vcc, 0, v225, vcc
    global_load_dword v236, v[224:225], off
    v_lshrrev_b32 v1, 6, v0
    v_and_b32 v232, 63, v0
    v_readfirstlane_b32 s3, v1
    v_bfe_u32 v228, v232, 2, 2
    v_lshlrev_b32 v1, 8, v228
    v_lshrrev_b32 v228, 4, v232
    v_lshl_add_u32 v1, v228, 6, v1
    v_and_b32 v228, 3, v232
    v_lshl_add_u32 v1, v228, 4, v1
    s_mul_i32 s32, s3, 4128
    s_mul_i32 s43, s3, 18432
    v_lshl_add_u32 v0, v232, 4, s43
    s_mul_i32 s41, s2, 73728
    s_lshl_b32 s42, s2, 17
    s_mov_b32 s34, 0
    s_mov_b32 s35, 0x40000000
    s_mov_b64 vcc, 0
    s_mov_b32 s67, 33423360
    s_mov_b32 s66, 33423360
L_wa:
    s_waitcnt lgkmcnt(0)
    s_add_u32 s16, s6, s42
    s_addc_u32 s17, s7, 0
    s_mov_b32 s18, 33685504
    s_mov_b32 s19, 0x20000
    s_add_u32 s12, s4, s41
    s_addc_u32 s13, s5, 0
    s_mov_b32 s14, 18948096
    s_mov_b32 s15, 0x20000
    s_add_u32 s20, s8, s42
    s_addc_u32 s21, s9, 0
    s_sub_u32 s20, s20, 2048
    s_subb_u32 s21, s21, 0
    s_mov_b32 s22, 33687552
    s_mov_b32 s23, 0x20000
    s_add_u32 s24, s10, s41
    s_addc_u32 s25, s11, 0
    s_mov_b32 s26, 18948096
    s_mov_b32 s27, 0x20000
L_start:
    s_lshl_b32 s31, s3, 11
    s_or_b32 s31, s31, s67
    s_xor_b32 s64, s31, s66
    s_add_u32 m0, s32, 66048
    s_xor_b32 s41, s34, 0
    s_mul_i32 s41, s41, 18874368
    s_mul_i32 s42, s3, 18432
    buffer_load_dwordx4 v1, s[16:19], s64 offen nt lds
    buffer_load_dwordx4 v1, s[16:19], s64 offen offset:1024 nt lds
    s_mov_b32 s65, s64
    s_add_u32 s31, s31, 8192
    s_or_b32 s31, s31, s67
    s_xor_b32 s64, s31, s66
    s_add_u32 s41, s41, s42
    s_and_b32 s42, s3, 1
    s_lshl_b32 s60, s42, 11
    s_add_u32 s60, s60, s41
    s_xor_b32 s42, s42, 1
    s_lshl_b32 s61, s42, 14
    s_add_u32 s61, s61, s41
    buffer_load_dwordx4 v[96:99], v1, s[12:15], s61 offen nt
    buffer_load_dwordx4 v[100:103], v1, s[12:15], s61 offen offset:1024 nt
    buffer_load_dwordx4 v[104:107], v1, s[12:15], s60 offen nt
    buffer_load_dwordx4 v[108:111], v1, s[12:15], s60 offen offset:1024 nt
    buffer_load_dwordx4 v[112:115], v1, s[12:15], s60 offen offset:2048 nt
    buffer_load_dwordx4 v[116:119], v1, s[12:15], s60 offen offset:3072 nt
    s_add_u32 s60, s60, 4096
    buffer_load_dwordx4 v[120:123], v1, s[12:15], s60 offen nt
    buffer_load_dwordx4 v[124:127], v1, s[12:15], s60 offen offset:1024 nt
    buffer_load_dwordx4 v[128:131], v1, s[12:15], s60 offen offset:2048 nt
    buffer_load_dwordx4 v[132:135], v1, s[12:15], s60 offen offset:3072 nt
    s_add_u32 s60, s60, 4096
    buffer_load_dwordx4 v[136:139], v1, s[12:15], s60 offen nt
    buffer_load_dwordx4 v[140:143], v1, s[12:15], s60 offen offset:1024 nt
    buffer_load_dwordx4 v[144:147], v1, s[12:15], s60 offen offset:2048 nt
    buffer_load_dwordx4 v[148:151], v1, s[12:15], s60 offen offset:3072 nt
    s_add_u32 s60, s60, 4096
    v_bfe_u32 v232, v0, 4, 6
    s_mov_b32 s28, 0x3e0293ee
    s_mov_b32 s29, 0x3e0293ee
    s_mov_b32 s44, 0x53800000
    s_mov_b32 s45, 0xffff0000
    s_mul_i32 s40, s3, 19584
    s_add_u32 s40, s40, 82560
    s_sub_u32 s39, 160896, s40
    v_and_b32 v229, 15, v232
    v_lshrrev_b32 v230, 4, v232
    v_lshlrev_b32 v15, 4, v230
    v_and_b32 v228, 3, v229
    v_lshl_add_u32 v231, v228, 6, v15
    v_lshlrev_b32 v3, 3, v228
    v_lshrrev_b32 v228, 2, v229
    v_lshl_add_u32 v3, v228, 6, v3
    v_mul_u32_u24 v2, 4128, v228
    v_add_u32 v2, v2, v231
    v_mul_u32_u24 v228, 4128, v230
    v_add_u32 v3, v3, v228
    v_bfe_u32 v228, v229, 2, 1
    v_lshl_add_u32 v231, v228, 10, v231
    v_lshrrev_b32 v228, 3, v229
    v_mul_u32_u24 v228, 2176, v228
    v_add_u32 v231, v231, v228
    s_and_b32 s41, s3, 1
    s_mul_i32 s41, s41, 2176
    s_add_u32 s41, s41, s40
    s_lshr_b32 s42, s3, 1
    s_mul_i32 s43, s42, 39168
    s_add_u32 s43, s43, 99968
    v_add_u32 v6, s41, v231
    v_add_u32 v7, s43, v231
    v_mul_u32_u24 v231, 272, v229
    v_lshl_add_u32 v231, v230, 3, v231
    v_add_u32 v8, s41, v231
    v_add_u32 v9, s43, v231
    v_mul_u32_u24 v231, 272, v230
    v_lshl_add_u32 v231, v229, 4, v231
    v_add_u32 v231, s40, v231
    v_accvgpr_write_b32 a226, v231
    v_lshl_add_u32 v11, v232, 4, s40
    v_mov_b32 v10, v11
    s_mul_i32 s41, s42, 8256
    v_lshl_add_u32 v12, v232, 4, s41
    s_lshl_b32 s41, s42, 7
    s_add_u32 s41, s41, 162944
    v_lshl_add_u32 v13, v229, 2, s41
    v_mov_b32 v14, 0
    v_add_u32 v4, 66048, v2
    v_mov_b32 v5, v3
    v_and_b32 v228, 3, v232
    v_cmp_eq_u32 s[48:49], 0, v228
    v_mov_b32 v231, 0x3f803f80
    s_nop 1
    v_cndmask_b32 v231, 0, v231, s[48:49]
    v_accvgpr_write_b32 a196, v231
    v_accvgpr_write_b32 a197, v231
    v_accvgpr_write_b32 a198, v231
    v_accvgpr_write_b32 a199, v231
    s_mov_b32 s30, 0
    s_mov_b32 s33, 14
    s_mov_b32 s36, s40
    s_mul_i32 s37, s3, 18432
    s_add_u32 s37, s37, 18874368
    s_mov_b32 s38, 4294965120
    s_and_b32 s41, s3, 1
    s_mul_i32 s42, s41, 2176
    v_add_u32 v226, s42, v11
    s_mul_i32 s42, s41, 17408
    v_subrev_u32 v227, s42, v11
    v_add_u32 v232, 66048, v15
    s_cmp_eq_u32 s3, 0
    s_cbranch_scc1 L_pb0
    s_cmp_eq_u32 s3, 1
    s_cbranch_scc1 L_pb1
    s_cmp_eq_u32 s3, 2
    s_cbranch_scc1 L_pb2
    s_cmp_eq_u32 s3, 3
    s_cbranch_scc1 L_pb3
L_wb0:
    s_cmp_eq_u32 s3, 0
    s_cbranch_scc1 L_pb4
    s_cmp_eq_u32 s3, 1
    s_cbranch_scc1 L_pb5
    s_cmp_eq_u32 s3, 2
    s_cbranch_scc1 L_pb6
    s_cmp_eq_u32 s3, 3
    s_cbranch_scc1 L_pb7
L_wb1:
    s_cmp_eq_u32 s3, 0
    s_cbranch_scc1 L_pb8
    s_cmp_eq_u32 s3, 1
    s_cbranch_scc1 L_pb9
    s_cmp_eq_u32 s3, 2
    s_cbranch_scc1 L_pb10
L_wb2:
    s_waitcnt vmcnt(13)
    buffer_load_dwordx4 v[152:155], v1, s[12:15], s60 offen nt
    v_lshlrev_b32 v228, 16, v96
    v_and_b32 v229, s45, v96
    v_pk_mul_f32 v[228:229], v[228:229], s[28:29]
    v_cvt_pk_bf16_f32 v96, v228, v229
    v_lshlrev_b32 v230, 16, v97
    v_and_b32 v231, s45, v97
    v_pk_mul_f32 v[230:231], v[230:231], s[28:29]
    v_cvt_pk_bf16_f32 v97, v230, v231
    v_lshlrev_b32 v228, 16, v98
    v_and_b32 v229, s45, v98
    v_pk_mul_f32 v[228:229], v[228:229], s[28:29]
    v_cvt_pk_bf16_f32 v98, v228, v229
    v_lshlrev_b32 v230, 16, v99
    v_and_b32 v231, s45, v99
    v_pk_mul_f32 v[230:231], v[230:231], s[28:29]
    v_cvt_pk_bf16_f32 v99, v230, v231
    ds_write_b128 v227, v[96:99] offset:17408
    s_waitcnt vmcnt(13)
    buffer_load_dwordx4 v[156:159], v1, s[12:15], s60 offen offset:1024 nt
    v_lshlrev_b32 v228, 16, v100
    v_and_b32 v229, s45, v100
    v_pk_mul_f32 v[228:229], v[228:229], s[28:29]
    v_cvt_pk_bf16_f32 v100, v228, v229
    v_lshlrev_b32 v230, 16, v101
    v_and_b32 v231, s45, v101
    v_pk_mul_f32 v[230:231], v[230:231], s[28:29]
    v_cvt_pk_bf16_f32 v101, v230, v231
    v_lshlrev_b32 v228, 16, v102
    v_and_b32 v229, s45, v102
    v_pk_mul_f32 v[228:229], v[228:229], s[28:29]
    v_cvt_pk_bf16_f32 v102, v228, v229
    v_lshlrev_b32 v230, 16, v103
    v_and_b32 v231, s45, v103
    v_pk_mul_f32 v[230:231], v[230:231], s[28:29]
    v_cvt_pk_bf16_f32 v103, v230, v231
    ds_write_b128 v227, v[100:103] offset:18432
    s_waitcnt lgkmcnt(0)
    s_barrier
    ds_read_b128 a[200:203], v232 offset:0
    ds_read_b128 a[204:207], v232 offset:256
    ds_read_b128 a[208:211], v232 offset:512
    ds_read_b128 a[212:215], v232 offset:768
    ds_read_b128 a[96:99], v7 offset:0
    ds_read_b128 a[100:103], v7 offset:256
    ds_read_b128 a[104:107], v7 offset:512
    ds_read_b128 a[108:111], v7 offset:768
    ds_read_b128 a[112:115], v4 offset:0
    ds_read_b128 a[116:119], v4 offset:256
    ds_read_b128 a[120:123], v4 offset:512
    ds_read_b128 a[124:127], v4 offset:768
    ds_read_b128 a[128:131], v4 offset:1024
    ds_read_b128 a[132:135], v4 offset:1280
    ds_read_b128 a[136:139], v4 offset:1536
    ds_read_b128 a[140:143], v4 offset:1792
    v_mov_b64 v[96:97], 0
    v_mov_b64 v[98:99], 0
    s_waitcnt vmcnt(13)
    buffer_load_dwordx4 v[160:163], v1, s[12:15], s60 offen offset:2048 nt
    v_lshlrev_b32 v228, 16, v104
    v_and_b32 v229, s45, v104
    v_pk_mul_f32 v[228:229], v[228:229], s[28:29]
    v_cvt_pk_bf16_f32 v104, v228, v229
    v_lshlrev_b32 v230, 16, v105
    v_and_b32 v231, s45, v105
    v_pk_mul_f32 v[230:231], v[230:231], s[28:29]
    v_cvt_pk_bf16_f32 v105, v230, v231
    v_lshlrev_b32 v228, 16, v106
    v_and_b32 v229, s45, v106
    v_pk_mul_f32 v[228:229], v[228:229], s[28:29]
    v_cvt_pk_bf16_f32 v106, v228, v229
    v_lshlrev_b32 v230, 16, v107
    v_and_b32 v231, s45, v107
    v_pk_mul_f32 v[230:231], v[230:231], s[28:29]
    v_cvt_pk_bf16_f32 v107, v230, v231
    ds_write_b128 v226, v[104:107] offset:0
    v_mov_b64 v[100:101], 0
    v_mov_b64 v[102:103], 0
    v_mov_b64 v[168:169], 0
    v_mov_b64 v[170:171], 0
    v_mov_b64 v[172:173], 0
    v_mov_b64 v[174:175], 0
    v_mov_b64 v[176:177], 0
    v_mov_b64 v[178:179], 0
    v_mov_b64 v[180:181], 0
    v_mov_b64 v[182:183], 0
    v_mov_b64 v[184:185], 0
    v_mov_b64 v[186:187], 0
    s_waitcnt vmcnt(13)
    buffer_load_dwordx4 v[164:167], v1, s[12:15], s60 offen offset:3072 nt
    s_add_u32 s60, s60, 4096
    v_lshlrev_b32 v228, 16, v108
    v_and_b32 v229, s45, v108
    v_pk_mul_f32 v[228:229], v[228:229], s[28:29]
    v_cvt_pk_bf16_f32 v108, v228, v229
    v_lshlrev_b32 v230, 16, v109
    v_and_b32 v231, s45, v109
    v_pk_mul_f32 v[230:231], v[230:231], s[28:29]
    v_cvt_pk_bf16_f32 v109, v230, v231
    v_lshlrev_b32 v228, 16, v110
    v_and_b32 v229, s45, v110
    v_pk_mul_f32 v[228:229], v[228:229], s[28:29]
    v_cvt_pk_bf16_f32 v110, v228, v229
    v_lshlrev_b32 v230, 16, v111
    v_and_b32 v231, s45, v111
    v_pk_mul_f32 v[230:231], v[230:231], s[28:29]
    v_cvt_pk_bf16_f32 v111, v230, v231
    ds_write_b128 v226, v[108:111] offset:1024
    v_mov_b64 v[104:105], 0
    v_mov_b64 v[106:107], 0
    v_mov_b64 v[188:189], 0
    v_mov_b64 v[190:191], 0
    v_mov_b64 v[192:193], 0
    v_mov_b64 v[194:195], 0
    v_mov_b64 v[196:197], 0
    v_mov_b64 v[198:199], 0
    v_mov_b64 v[200:201], 0
    v_mov_b64 v[202:203], 0
    v_mov_b64 v[204:205], 0
    v_mov_b64 v[206:207], 0
    s_waitcnt vmcnt(13)
    s_add_u32 m0, s32, 0
    s_nop 0
    buffer_load_dwordx4 v1, s[16:19], s64 offen nt lds
    v_lshlrev_b32 v228, 16, v112
    v_and_b32 v229, s45, v112
    v_pk_mul_f32 v[228:229], v[228:229], s[28:29]
    v_cvt_pk_bf16_f32 v112, v228, v229
    v_lshlrev_b32 v230, 16, v113
    v_and_b32 v231, s45, v113
    v_pk_mul_f32 v[230:231], v[230:231], s[28:29]
    v_cvt_pk_bf16_f32 v113, v230, v231
    v_lshlrev_b32 v228, 16, v114
    v_and_b32 v229, s45, v114
    v_pk_mul_f32 v[228:229], v[228:229], s[28:29]
    v_cvt_pk_bf16_f32 v114, v228, v229
    v_lshlrev_b32 v230, 16, v115
    v_and_b32 v231, s45, v115
    v_pk_mul_f32 v[230:231], v[230:231], s[28:29]
    v_cvt_pk_bf16_f32 v115, v230, v231
    s_waitcnt lgkmcnt(0)
    v_mfma_f32_16x16x32_bf16 v[92:95], a[200:203], a[96:99], 0
    v_mfma_f32_16x16x32_bf16 v[92:95], a[204:207], a[100:103], v[92:95]
    v_mfma_f32_16x16x32_bf16 v[92:95], a[208:211], a[104:107], v[92:95]
    v_mfma_f32_16x16x32_bf16 v[92:95], a[212:215], a[108:111], v[92:95]
    ds_write_b128 v226, v[112:115] offset:2176
    v_mov_b64 v[108:109], 0
    v_mov_b64 v[110:111], 0
    v_mov_b64 v[208:209], 0
    v_mov_b64 v[210:211], 0
    v_mov_b64 v[212:213], 0
    v_mov_b64 v[214:215], 0
    v_mov_b64 v[216:217], 0
    v_mov_b64 v[218:219], 0
    v_mov_b64 v[220:221], 0
    v_mov_b64 v[222:223], 0
    v_mov_b64 v[64:65], 0
    v_mov_b64 v[66:67], 0
    s_waitcnt vmcnt(13)
    buffer_load_dwordx4 v1, s[16:19], s64 offen offset:1024 nt lds
    v_lshlrev_b32 v228, 16, v116
    v_and_b32 v229, s45, v116
    v_pk_mul_f32 v[228:229], v[228:229], s[28:29]
    v_cvt_pk_bf16_f32 v116, v228, v229
    v_lshlrev_b32 v230, 16, v117
    v_and_b32 v231, s45, v117
    v_pk_mul_f32 v[230:231], v[230:231], s[28:29]
    v_cvt_pk_bf16_f32 v117, v230, v231
    v_lshlrev_b32 v228, 16, v118
    v_and_b32 v229, s45, v118
    v_pk_mul_f32 v[228:229], v[228:229], s[28:29]
    v_cvt_pk_bf16_f32 v118, v228, v229
    v_lshlrev_b32 v230, 16, v119
    v_and_b32 v231, s45, v119
    v_pk_mul_f32 v[230:231], v[230:231], s[28:29]
    v_cvt_pk_bf16_f32 v119, v230, v231
    v_sub_f32 v92, 0, v92
    v_sub_f32 v93, 0, v93
    v_sub_f32 v94, 0, v94
    v_sub_f32 v95, 0, v95
    ds_write_b128 v226, v[116:119] offset:3200
    ds_read_b128 a[32:35], v6 offset:0
    ds_read_b128 a[36:39], v6 offset:256
    ds_read_b128 a[40:43], v6 offset:512
    ds_read_b128 a[44:47], v6 offset:768
    v_mov_b64 v[112:113], 0
    v_mov_b64 v[114:115], 0
    v_mov_b64 v[68:69], 0
    v_mov_b64 v[70:71], 0
    v_accvgpr_write_b32 a0, 0
    v_accvgpr_write_b32 a1, 0
    v_accvgpr_write_b32 a2, 0
    v_accvgpr_write_b32 a3, 0
    v_accvgpr_write_b32 a4, 0
    v_accvgpr_write_b32 a5, 0
    v_accvgpr_write_b32 a6, 0
    v_accvgpr_write_b32 a7, 0
    s_waitcnt vmcnt(13)
    buffer_load_dwordx4 v1, s[20:23], s65 offen offset:2048 nt lds
    v_lshlrev_b32 v228, 16, v120
    v_and_b32 v229, s45, v120
    v_pk_mul_f32 v[228:229], v[228:229], s[28:29]
    v_cvt_pk_bf16_f32 v120, v228, v229
    v_lshlrev_b32 v230, 16, v121
    v_and_b32 v231, s45, v121
    v_pk_mul_f32 v[230:231], v[230:231], s[28:29]
    v_cvt_pk_bf16_f32 v121, v230, v231
    v_lshlrev_b32 v228, 16, v122
    v_and_b32 v229, s45, v122
    v_pk_mul_f32 v[228:229], v[228:229], s[28:29]
    v_cvt_pk_bf16_f32 v122, v228, v229
    v_lshlrev_b32 v230, 16, v123
    v_and_b32 v231, s45, v123
    v_pk_mul_f32 v[230:231], v[230:231], s[28:29]
    v_cvt_pk_bf16_f32 v123, v230, v231
    ds_write_b128 v226, v[120:123] offset:4352
    v_mov_b64 v[116:117], 0
    v_mov_b64 v[118:119], 0
    v_accvgpr_write_b32 a8, 0
    v_accvgpr_write_b32 a9, 0
    v_accvgpr_write_b32 a10, 0
    v_accvgpr_write_b32 a11, 0
    v_accvgpr_write_b32 a12, 0
    v_accvgpr_write_b32 a13, 0
    v_accvgpr_write_b32 a14, 0
    v_accvgpr_write_b32 a15, 0
    v_accvgpr_write_b32 a16, 0
    v_accvgpr_write_b32 a17, 0
    s_waitcnt vmcnt(13)
    buffer_load_dwordx4 v1, s[20:23], s65 offen offset:3072 nt lds
    s_mov_b32 s65, s64
    s_add_u32 s31, s31, 8192
    s_or_b32 s31, s31, s67
    s_xor_b32 s64, s31, s66
    buffer_load_dword v236, v0, s[12:15], s35 offen
    buffer_load_dword v237, v0, s[12:15], s35 offen
    v_lshlrev_b32 v228, 16, v124
    v_and_b32 v229, s45, v124
    v_pk_mul_f32 v[228:229], v[228:229], s[28:29]
    v_cvt_pk_bf16_f32 v124, v228, v229
    v_lshlrev_b32 v230, 16, v125
    v_and_b32 v231, s45, v125
    v_pk_mul_f32 v[230:231], v[230:231], s[28:29]
    v_cvt_pk_bf16_f32 v125, v230, v231
    v_lshlrev_b32 v228, 16, v126
    v_and_b32 v229, s45, v126
    v_pk_mul_f32 v[228:229], v[228:229], s[28:29]
    v_cvt_pk_bf16_f32 v126, v228, v229
    v_lshlrev_b32 v230, 16, v127
    v_and_b32 v231, s45, v127
    v_pk_mul_f32 v[230:231], v[230:231], s[28:29]
    v_cvt_pk_bf16_f32 v127, v230, v231
    s_waitcnt lgkmcnt(0)
    v_mfma_f32_16x16x32_bf16 v[76:79], a[200:203], a[32:35], 0
    v_mfma_f32_16x16x32_bf16 v[76:79], a[204:207], a[36:39], v[76:79]
    v_mfma_f32_16x16x32_bf16 v[76:79], a[208:211], a[40:43], v[76:79]
    v_mfma_f32_16x16x32_bf16 v[76:79], a[212:215], a[44:47], v[76:79]
    ds_write_b128 v226, v[124:127] offset:5376
    v_mov_b64 v[120:121], 0
    v_mov_b64 v[122:123], 0
    v_accvgpr_write_b32 a18, 0
    v_accvgpr_write_b32 a19, 0
    v_accvgpr_write_b32 a20, 0
    v_accvgpr_write_b32 a21, 0
    v_accvgpr_write_b32 a22, 0
    v_accvgpr_write_b32 a23, 0
    v_accvgpr_write_b32 a24, 0
    v_accvgpr_write_b32 a25, 0
    v_accvgpr_write_b32 a26, 0
    v_accvgpr_write_b32 a27, 0
    s_waitcnt vmcnt(15)
    s_add_u32 m0, s32, 16512
    s_nop 0
    buffer_load_dwordx4 v1, s[16:19], s64 offen nt lds
    v_lshlrev_b32 v228, 16, v128
    v_and_b32 v229, s45, v128
    v_pk_mul_f32 v[228:229], v[228:229], s[28:29]
    v_cvt_pk_bf16_f32 v128, v228, v229
    v_lshlrev_b32 v230, 16, v129
    v_and_b32 v231, s45, v129
    v_pk_mul_f32 v[230:231], v[230:231], s[28:29]
    v_cvt_pk_bf16_f32 v129, v230, v231
    v_lshlrev_b32 v228, 16, v130
    v_and_b32 v229, s45, v130
    v_pk_mul_f32 v[228:229], v[228:229], s[28:29]
    v_cvt_pk_bf16_f32 v130, v228, v229
    v_lshlrev_b32 v230, 16, v131
    v_and_b32 v231, s45, v131
    v_pk_mul_f32 v[230:231], v[230:231], s[28:29]
    v_cvt_pk_bf16_f32 v131, v230, v231
    v_sub_f32 v76, 0, v76
    v_sub_f32 v77, 0, v77
    v_sub_f32 v78, 0, v78
    v_sub_f32 v79, 0, v79
    ds_write_b128 v226, v[128:131] offset:6528
    v_mov_b64 v[124:125], 0
    v_mov_b64 v[126:127], 0
    v_accvgpr_write_b32 a28, 0
    v_accvgpr_write_b32 a29, 0
    v_accvgpr_write_b32 a30, 0
    v_accvgpr_write_b32 a31, 0
    v_accvgpr_write_b32 a144, 0
    v_accvgpr_write_b32 a145, 0
    v_accvgpr_write_b32 a146, 0
    v_accvgpr_write_b32 a147, 0
    v_accvgpr_write_b32 a148, 0
    v_accvgpr_write_b32 a149, 0
    s_waitcnt vmcnt(15)
    buffer_load_dwordx4 v1, s[16:19], s64 offen offset:1024 nt lds
    v_lshlrev_b32 v228, 16, v132
    v_and_b32 v229, s45, v132
    v_pk_mul_f32 v[228:229], v[228:229], s[28:29]
    v_cvt_pk_bf16_f32 v132, v228, v229
    v_lshlrev_b32 v230, 16, v133
    v_and_b32 v231, s45, v133
    v_pk_mul_f32 v[230:231], v[230:231], s[28:29]
    v_cvt_pk_bf16_f32 v133, v230, v231
    v_lshlrev_b32 v228, 16, v134
    v_and_b32 v229, s45, v134
    v_pk_mul_f32 v[228:229], v[228:229], s[28:29]
    v_cvt_pk_bf16_f32 v134, v228, v229
    v_lshlrev_b32 v230, 16, v135
    v_and_b32 v231, s45, v135
    v_pk_mul_f32 v[230:231], v[230:231], s[28:29]
    v_cvt_pk_bf16_f32 v135, v230, v231
    v_mfma_f32_16x16x32_bf16 v[16:19], a[112:115], a[32:35], v[76:79]
    v_mfma_f32_16x16x32_bf16 v[16:19], a[116:119], a[36:39], v[16:19]
    v_mfma_f32_16x16x32_bf16 v[16:19], a[120:123], a[40:43], v[16:19]
    v_mfma_f32_16x16x32_bf16 v[16:19], a[124:127], a[44:47], v[16:19]
    v_mfma_f32_16x16x32_bf16 v[20:23], a[128:131], a[32:35], v[76:79]
    v_mfma_f32_16x16x32_bf16 v[20:23], a[132:135], a[36:39], v[20:23]
    v_mfma_f32_16x16x32_bf16 v[20:23], a[136:139], a[40:43], v[20:23]
    v_mfma_f32_16x16x32_bf16 v[20:23], a[140:143], a[44:47], v[20:23]
    ds_write_b128 v226, v[132:135] offset:7552
    ds_read_b128 a[48:51], v6 offset:4352
    ds_read_b128 a[52:55], v6 offset:4608
    ds_read_b128 a[56:59], v6 offset:4864
    ds_read_b128 a[60:63], v6 offset:5120
    v_mov_b64 v[128:129], 0
    v_mov_b64 v[130:131], 0
    v_accvgpr_write_b32 a150, 0
    v_accvgpr_write_b32 a151, 0
    v_accvgpr_write_b32 a152, 0
    v_accvgpr_write_b32 a153, 0
    v_accvgpr_write_b32 a154, 0
    v_accvgpr_write_b32 a155, 0
    v_accvgpr_write_b32 a156, 0
    v_accvgpr_write_b32 a157, 0
    v_accvgpr_write_b32 a158, 0
    v_accvgpr_write_b32 a159, 0
    s_waitcnt vmcnt(15)
    buffer_load_dwordx4 v1, s[20:23], s65 offen offset:2048 nt lds
    v_lshlrev_b32 v228, 16, v136
    v_and_b32 v229, s45, v136
    v_pk_mul_f32 v[228:229], v[228:229], s[28:29]
    v_cvt_pk_bf16_f32 v136, v228, v229
    v_lshlrev_b32 v230, 16, v137
    v_and_b32 v231, s45, v137
    v_pk_mul_f32 v[230:231], v[230:231], s[28:29]
    v_cvt_pk_bf16_f32 v137, v230, v231
    v_lshlrev_b32 v228, 16, v138
    v_and_b32 v229, s45, v138
    v_pk_mul_f32 v[228:229], v[228:229], s[28:29]
    v_cvt_pk_bf16_f32 v138, v228, v229
    v_lshlrev_b32 v230, 16, v139
    v_and_b32 v231, s45, v139
    v_pk_mul_f32 v[230:231], v[230:231], s[28:29]
    v_cvt_pk_bf16_f32 v139, v230, v231
    ds_write_b128 v226, v[136:139] offset:8704
    v_mov_b64 v[132:133], 0
    v_mov_b64 v[134:135], 0
    v_accvgpr_write_b32 a160, 0
    v_accvgpr_write_b32 a161, 0
    v_accvgpr_write_b32 a162, 0
    v_accvgpr_write_b32 a163, 0
    v_accvgpr_write_b32 a164, 0
    v_accvgpr_write_b32 a165, 0
    v_accvgpr_write_b32 a166, 0
    v_accvgpr_write_b32 a167, 0
    v_accvgpr_write_b32 a168, 0
    v_accvgpr_write_b32 a169, 0
    s_waitcnt vmcnt(15)
    buffer_load_dwordx4 v1, s[20:23], s65 offen offset:3072 nt lds
    s_mov_b32 s65, s64
    s_add_u32 s31, s31, 8192
    s_or_b32 s31, s31, s67
    s_xor_b32 s64, s31, s66
    buffer_load_dword v236, v0, s[12:15], s35 offen
    buffer_load_dword v237, v0, s[12:15], s35 offen
    v_lshlrev_b32 v228, 16, v140
    v_and_b32 v229, s45, v140
    v_pk_mul_f32 v[228:229], v[228:229], s[28:29]
    v_cvt_pk_bf16_f32 v140, v228, v229
    v_lshlrev_b32 v230, 16, v141
    v_and_b32 v231, s45, v141
    v_pk_mul_f32 v[230:231], v[230:231], s[28:29]
    v_cvt_pk_bf16_f32 v141, v230, v231
    v_lshlrev_b32 v228, 16, v142
    v_and_b32 v229, s45, v142
    v_pk_mul_f32 v[228:229], v[228:229], s[28:29]
    v_cvt_pk_bf16_f32 v142, v228, v229
    v_lshlrev_b32 v230, 16, v143
    v_and_b32 v231, s45, v143
    v_pk_mul_f32 v[230:231], v[230:231], s[28:29]
    v_cvt_pk_bf16_f32 v143, v230, v231
    s_waitcnt lgkmcnt(0)
    v_mfma_f32_16x16x32_bf16 v[80:83], a[200:203], a[48:51], 0
    v_mfma_f32_16x16x32_bf16 v[80:83], a[204:207], a[52:55], v[80:83]
    v_mfma_f32_16x16x32_bf16 v[80:83], a[208:211], a[56:59], v[80:83]
    v_mfma_f32_16x16x32_bf16 v[80:83], a[212:215], a[60:63], v[80:83]
    ds_write_b128 v226, v[140:143] offset:9728
    v_mov_b64 v[136:137], 0
    v_mov_b64 v[138:139], 0
    v_accvgpr_write_b32 a170, 0
    v_accvgpr_write_b32 a171, 0
    v_accvgpr_write_b32 a172, 0
    v_accvgpr_write_b32 a173, 0
    v_accvgpr_write_b32 a174, 0
    v_accvgpr_write_b32 a175, 0
    v_accvgpr_write_b32 a176, 0
    v_accvgpr_write_b32 a177, 0
    v_accvgpr_write_b32 a178, 0
    v_accvgpr_write_b32 a179, 0
    s_waitcnt vmcnt(17)
    s_add_u32 m0, s32, 33024
    s_nop 0
    buffer_load_dwordx4 v1, s[16:19], s64 offen nt lds
    v_lshlrev_b32 v228, 16, v144
    v_and_b32 v229, s45, v144
    v_pk_mul_f32 v[228:229], v[228:229], s[28:29]
    v_cvt_pk_bf16_f32 v144, v228, v229
    v_lshlrev_b32 v230, 16, v145
    v_and_b32 v231, s45, v145
    v_pk_mul_f32 v[230:231], v[230:231], s[28:29]
    v_cvt_pk_bf16_f32 v145, v230, v231
    v_lshlrev_b32 v228, 16, v146
    v_and_b32 v229, s45, v146
    v_pk_mul_f32 v[228:229], v[228:229], s[28:29]
    v_cvt_pk_bf16_f32 v146, v228, v229
    v_lshlrev_b32 v230, 16, v147
    v_and_b32 v231, s45, v147
    v_pk_mul_f32 v[230:231], v[230:231], s[28:29]
    v_cvt_pk_bf16_f32 v147, v230, v231
    v_sub_f32 v80, 0, v80
    v_sub_f32 v81, 0, v81
    v_sub_f32 v82, 0, v82
    v_sub_f32 v83, 0, v83
    ds_write_b128 v226, v[144:147] offset:10880
    v_mov_b64 v[140:141], 0
    v_mov_b64 v[142:143], 0
    v_accvgpr_write_b32 a180, 0
    v_accvgpr_write_b32 a181, 0
    v_accvgpr_write_b32 a182, 0
    v_accvgpr_write_b32 a183, 0
    v_accvgpr_write_b32 a184, 0
    v_accvgpr_write_b32 a185, 0
    v_accvgpr_write_b32 a186, 0
    v_accvgpr_write_b32 a187, 0
    v_accvgpr_write_b32 a188, 0
    v_accvgpr_write_b32 a189, 0
    s_waitcnt vmcnt(17)
    buffer_load_dwordx4 v1, s[16:19], s64 offen offset:1024 nt lds
    v_lshlrev_b32 v228, 16, v148
    v_and_b32 v229, s45, v148
    s_branch L_pg0
    .p2align 12
L_pa0:
    s_branch L_wa
L_pb0:
    s_branch L_wb0
L_pg0:
    v_pk_mul_f32 v[228:229], v[228:229], s[28:29]
    v_cvt_pk_bf16_f32 v148, v228, v229
    v_lshlrev_b32 v230, 16, v149
    v_and_b32 v231, s45, v149
    v_pk_mul_f32 v[230:231], v[230:231], s[28:29]
    v_cvt_pk_bf16_f32 v149, v230, v231
    v_lshlrev_b32 v228, 16, v150
    v_and_b32 v229, s45, v150
    v_pk_mul_f32 v[228:229], v[228:229], s[28:29]
    v_cvt_pk_bf16_f32 v150, v228, v229
    v_lshlrev_b32 v230, 16, v151
    v_and_b32 v231, s45, v151
    v_pk_mul_f32 v[230:231], v[230:231], s[28:29]
    v_cvt_pk_bf16_f32 v151, v230, v231
    ds_write_b128 v226, v[148:151] offset:11904
    ds_read_b128 a[64:67], v6 offset:8704
    ds_read_b128 a[68:71], v6 offset:8960
    ds_read_b128 a[72:75], v6 offset:9216
    ds_read_b128 a[76:79], v6 offset:9472
    v_mov_b64 v[144:145], 0
    v_mov_b64 v[146:147], 0
    v_accvgpr_write_b32 a190, 0
    v_accvgpr_write_b32 a191, 0
    v_accvgpr_write_b32 a192, 0
    v_accvgpr_write_b32 a193, 0
    v_accvgpr_write_b32 a194, 0
    v_accvgpr_write_b32 a195, 0
    s_waitcnt vmcnt(17)
    buffer_load_dwordx4 v1, s[20:23], s65 offen offset:2048 nt lds
    v_lshlrev_b32 v228, 16, v152
    v_and_b32 v229, s45, v152
    v_pk_mul_f32 v[228:229], v[228:229], s[28:29]
    v_cvt_pk_bf16_f32 v152, v228, v229
    v_lshlrev_b32 v230, 16, v153
    v_and_b32 v231, s45, v153
    v_pk_mul_f32 v[230:231], v[230:231], s[28:29]
    v_cvt_pk_bf16_f32 v153, v230, v231
    v_lshlrev_b32 v228, 16, v154
    v_and_b32 v229, s45, v154
    v_pk_mul_f32 v[228:229], v[228:229], s[28:29]
    v_cvt_pk_bf16_f32 v154, v228, v229
    v_lshlrev_b32 v230, 16, v155
    v_and_b32 v231, s45, v155
    v_pk_mul_f32 v[230:231], v[230:231], s[28:29]
    v_cvt_pk_bf16_f32 v155, v230, v231
    ds_write_b128 v226, v[152:155] offset:13056
    v_mov_b64 v[148:149], 0
    v_mov_b64 v[150:151], 0
    s_waitcnt vmcnt(17)
    buffer_load_dwordx4 v1, s[20:23], s65 offen offset:3072 nt lds
    s_mov_b32 s65, s64
    s_add_u32 s31, s31, 8192
    s_or_b32 s31, s31, s67
    s_xor_b32 s64, s31, s66
    buffer_load_dword v236, v0, s[12:15], s35 offen
    buffer_load_dword v237, v0, s[12:15], s35 offen
    v_lshlrev_b32 v228, 16, v156
    v_and_b32 v229, s45, v156
    v_pk_mul_f32 v[228:229], v[228:229], s[28:29]
    v_cvt_pk_bf16_f32 v156, v228, v229
    v_lshlrev_b32 v230, 16, v157
    v_and_b32 v231, s45, v157
    v_pk_mul_f32 v[230:231], v[230:231], s[28:29]
    v_cvt_pk_bf16_f32 v157, v230, v231
    v_lshlrev_b32 v228, 16, v158
    v_and_b32 v229, s45, v158
    v_pk_mul_f32 v[228:229], v[228:229], s[28:29]
    v_cvt_pk_bf16_f32 v158, v228, v229
    v_lshlrev_b32 v230, 16, v159
    v_and_b32 v231, s45, v159
    v_pk_mul_f32 v[230:231], v[230:231], s[28:29]
    v_cvt_pk_bf16_f32 v159, v230, v231
    s_waitcnt lgkmcnt(0)
    v_mfma_f32_16x16x32_bf16 v[84:87], a[200:203], a[64:67], 0
    v_mfma_f32_16x16x32_bf16 v[84:87], a[204:207], a[68:71], v[84:87]
    v_mfma_f32_16x16x32_bf16 v[84:87], a[208:211], a[72:75], v[84:87]
    v_mfma_f32_16x16x32_bf16 v[84:87], a[212:215], a[76:79], v[84:87]
    ds_write_b128 v226, v[156:159] offset:14080
    v_mov_b64 v[152:153], 0
    v_mov_b64 v[154:155], 0
    s_waitcnt vmcnt(19)
    s_add_u32 m0, s32, 49536
    s_nop 0
    buffer_load_dwordx4 v1, s[16:19], s64 offen nt lds
    v_lshlrev_b32 v228, 16, v160
    v_and_b32 v229, s45, v160
    v_pk_mul_f32 v[228:229], v[228:229], s[28:29]
    v_cvt_pk_bf16_f32 v160, v228, v229
    v_lshlrev_b32 v230, 16, v161
    v_and_b32 v231, s45, v161
    v_pk_mul_f32 v[230:231], v[230:231], s[28:29]
    v_cvt_pk_bf16_f32 v161, v230, v231
    v_lshlrev_b32 v228, 16, v162
    v_and_b32 v229, s45, v162
    v_pk_mul_f32 v[228:229], v[228:229], s[28:29]
    v_cvt_pk_bf16_f32 v162, v228, v229
    v_lshlrev_b32 v230, 16, v163
    v_and_b32 v231, s45, v163
    v_pk_mul_f32 v[230:231], v[230:231], s[28:29]
    v_cvt_pk_bf16_f32 v163, v230, v231
    v_sub_f32 v84, 0, v84
    v_sub_f32 v85, 0, v85
    v_sub_f32 v86, 0, v86
    v_sub_f32 v87, 0, v87
    ds_write_b128 v226, v[160:163] offset:15232
    v_mov_b64 v[156:157], 0
    v_mov_b64 v[158:159], 0
    s_waitcnt vmcnt(19)
    buffer_load_dwordx4 v1, s[16:19], s64 offen offset:1024 nt lds
    v_lshlrev_b32 v228, 16, v164
    v_and_b32 v229, s45, v164
    v_pk_mul_f32 v[228:229], v[228:229], s[28:29]
    v_cvt_pk_bf16_f32 v164, v228, v229
    v_lshlrev_b32 v230, 16, v165
    v_and_b32 v231, s45, v165
    v_pk_mul_f32 v[230:231], v[230:231], s[28:29]
    v_cvt_pk_bf16_f32 v165, v230, v231
    v_lshlrev_b32 v228, 16, v166
    v_and_b32 v229, s45, v166
    v_pk_mul_f32 v[228:229], v[228:229], s[28:29]
    v_cvt_pk_bf16_f32 v166, v228, v229
    v_lshlrev_b32 v230, 16, v167
    v_and_b32 v231, s45, v167
    v_pk_mul_f32 v[230:231], v[230:231], s[28:29]
    v_cvt_pk_bf16_f32 v167, v230, v231
    ds_write_b128 v226, v[164:167] offset:16256
    ds_read_b128 a[80:83], v6 offset:13056
    ds_read_b128 a[84:87], v6 offset:13312
    ds_read_b128 a[88:91], v6 offset:13568
    ds_read_b128 a[92:95], v6 offset:13824
    v_mov_b64 v[160:161], 0
    v_mov_b64 v[162:163], 0
    buffer_load_dwordx4 v1, s[20:23], s65 offen offset:2048 nt lds
    buffer_load_dwordx4 v1, s[20:23], s65 offen offset:3072 nt lds
    s_mov_b32 s65, s64
    s_add_u32 s31, s31, 8192
    s_or_b32 s31, s31, s67
    s_xor_b32 s64, s31, s66
    buffer_load_dword v236, v0, s[12:15], s35 offen
    buffer_load_dword v237, v0, s[12:15], s35 offen
    s_add_u32 m0, s32, 66048
    v_mov_b64 v[164:165], 0
    v_mov_b64 v[166:167], 0
    s_cbranch_vccnz L_prepass
    s_waitcnt lgkmcnt(0)
    v_mfma_f32_16x16x32_bf16 v[88:91], a[200:203], a[80:83], 0
    v_mfma_f32_16x16x32_bf16 v[88:91], a[204:207], a[84:87], v[88:91]
    v_mfma_f32_16x16x32_bf16 v[88:91], a[208:211], a[88:91], v[88:91]
    v_mfma_f32_16x16x32_bf16 v[88:91], a[212:215], a[92:95], v[88:91]
    s_nop 7
    v_sub_f32 v88, 0, v88
    v_sub_f32 v89, 0, v89
    v_sub_f32 v90, 0, v90
    v_sub_f32 v91, 0, v91
L_fix0r:
    v_mov_b32 v4, v2
    s_bitcmp1_b32 s3, 0
    s_cbranch_scc0 L_N0
    v_mfma_f32_16x16x32_bf16 v[24:27], a[112:115], a[48:51], v[80:83]
    v_exp_f32 v16, v16
    v_mfma_f32_16x16x32_bf16 v[24:27], a[116:119], a[52:55], v[24:27]
    s_waitcnt vmcnt(20)
    s_barrier
    v_mfma_f32_16x16x32_bf16 v[24:27], a[120:123], a[56:59], v[24:27]
    v_exp_f32 v17, v17
    v_mfma_f32_16x16x32_bf16 v[24:27], a[124:127], a[60:63], v[24:27]
    v_cvt_pk_bf16_f32 v56, v16, v17
    v_mfma_f32_16x16x32_bf16 v[28:31], a[128:131], a[48:51], v[80:83]
    v_exp_f32 v18, v18
    v_mfma_f32_16x16x32_bf16 v[28:31], a[132:135], a[52:55], v[28:31]
    buffer_load_dwordx4 v1, s[16:19], s64 offen nt lds
    v_mfma_f32_16x16x32_bf16 v[28:31], a[136:139], a[56:59], v[28:31]
    v_exp_f32 v19, v19
    v_mfma_f32_16x16x32_bf16 v[28:31], a[140:143], a[60:63], v[28:31]
    v_cvt_pk_bf16_f32 v57, v18, v19
    v_mfma_f32_16x16x32_bf16 a[184:187], a[196:199], v[64:67], a[184:187]
    v_exp_f32 v20, v20
    v_mfma_f32_16x16x32_bf16 a[188:191], a[196:199], v[68:71], a[188:191]
    buffer_load_dwordx4 v1, s[16:19], s64 offen offset:1024 nt lds
    v_mfma_f32_16x16x32_bf16 v[160:163], a[144:147], v[64:67], v[160:163]
    v_exp_f32 v21, v21
    v_mfma_f32_16x16x32_bf16 v[192:195], a[144:147], v[68:71], v[192:195]
    ds_read_b64_tr_b16 a[144:145], v5 offset:2048
    v_cvt_pk_bf16_f32 v58, v20, v21
    v_mfma_f32_16x16x32_bf16 v[196:199], a[148:151], v[68:71], v[196:199]
    v_exp_f32 v22, v22
    v_mfma_f32_16x16x32_bf16 v[164:167], a[148:151], v[64:67], v[164:167]
    buffer_load_dwordx4 v1, s[20:23], s65 offen offset:2048 nt lds
    v_mfma_f32_16x16x32_bf16 v[168:171], a[152:155], v[64:67], v[168:171]
    v_exp_f32 v23, v23
    v_mfma_f32_16x16x32_bf16 v[200:203], a[152:155], v[68:71], v[200:203]
    ds_read_b64_tr_b16 a[146:147], v5 offset:3072
    v_cvt_pk_bf16_f32 v59, v22, v23
    v_mfma_f32_16x16x32_bf16 v[204:207], a[156:159], v[68:71], v[204:207]
    buffer_load_dwordx4 v1, s[20:23], s65 offen offset:3072 nt lds
    v_mfma_f32_16x16x32_bf16 v[172:175], a[156:159], v[64:67], v[172:175]
    s_mov_b32 s65, s64
    v_exp_f32 v24, v24
    v_mfma_f32_16x16x32_bf16 v[176:179], a[160:163], v[64:67], v[176:179]
    s_add_u32 s31, s31, 8192
    ds_read_b64_tr_b16 a[148:149], v5 offset:2080
    ds_read_b64_tr_b16 a[150:151], v5 offset:3104
    v_mfma_f32_16x16x32_bf16 v[208:211], a[160:163], v[68:71], v[208:211]
    s_or_b32 s31, s31, s67
    v_exp_f32 v25, v25
    v_mfma_f32_16x16x32_bf16 v[212:215], a[164:167], v[68:71], v[212:215]
    s_xor_b32 s64, s31, s66
    ds_read_b64_tr_b16 a[152:153], v5 offset:2304
    v_cvt_pk_bf16_f32 v60, v24, v25
    v_mfma_f32_16x16x32_bf16 v[180:183], a[164:167], v[64:67], v[180:183]
    s_mov_b32 m0, s36
    v_exp_f32 v26, v26
    v_mfma_f32_16x16x32_bf16 v[184:187], a[168:171], v[64:67], v[184:187]
    ds_read_b64_tr_b16 a[154:155], v5 offset:3328
    ds_read_b64_tr_b16 a[156:157], v5 offset:2336
    v_mfma_f32_16x16x32_bf16 v[216:219], a[168:171], v[68:71], v[216:219]
    v_exp_f32 v27, v27
    v_mfma_f32_16x16x32_bf16 v[220:223], a[172:175], v[68:71], v[220:223]
    ds_read_b64_tr_b16 a[158:159], v5 offset:3360
    v_cvt_pk_bf16_f32 v61, v26, v27
    v_mfma_f32_16x16x32_bf16 v[188:191], a[172:175], v[64:67], v[188:191]
    v_exp_f32 v28, v28
    v_mfma_f32_16x16x32_bf16 v[32:35], a[112:115], a[64:67], v[84:87]
    ds_read_b64_tr_b16 a[160:161], v5 offset:2560
    ds_read_b64_tr_b16 a[162:163], v5 offset:3584
    v_mfma_f32_16x16x32_bf16 v[32:35], a[116:119], a[68:71], v[32:35]
    v_exp_f32 v29, v29
    v_mfma_f32_16x16x32_bf16 v[32:35], a[120:123], a[72:75], v[32:35]
    ds_read_b64_tr_b16 a[164:165], v5 offset:2592
    v_cvt_pk_bf16_f32 v62, v28, v29
    v_mfma_f32_16x16x32_bf16 v[32:35], a[124:127], a[76:79], v[32:35]
    v_exp_f32 v30, v30
    v_mfma_f32_16x16x32_bf16 v[36:39], a[128:131], a[64:67], v[84:87]
    ds_read_b64_tr_b16 a[166:167], v5 offset:3616
    ds_read_b64_tr_b16 a[168:169], v5 offset:2816
    v_mfma_f32_16x16x32_bf16 v[36:39], a[132:135], a[68:71], v[36:39]
    v_exp_f32 v31, v31
    v_mfma_f32_16x16x32_bf16 v[36:39], a[136:139], a[72:75], v[36:39]
    ds_read_b64_tr_b16 a[170:171], v5 offset:3840
    v_cvt_pk_bf16_f32 v63, v30, v31
    v_mfma_f32_16x16x32_bf16 v[36:39], a[140:143], a[76:79], v[36:39]
    ds_read_b64_tr_b16 a[172:173], v5 offset:2848
    ds_read_b64_tr_b16 a[174:175], v5 offset:3872
    v_mfma_f32_16x16x32_bf16 v[40:43], a[112:115], a[80:83], v[88:91]
    v_exp_f32 v32, v32
    v_mfma_f32_16x16x32_bf16 v[40:43], a[116:119], a[84:87], v[40:43]
    ds_read_b128 a[112:115], v4 offset:0
    ds_read_b128 a[116:119], v4 offset:256
    v_mfma_f32_16x16x32_bf16 v[40:43], a[120:123], a[88:91], v[40:43]
    v_exp_f32 v33, v33
    v_mfma_f32_16x16x32_bf16 v[40:43], a[124:127], a[92:95], v[40:43]
    ds_read_b128 a[120:123], v4 offset:512
    v_cvt_pk_bf16_f32 v64, v32, v33
    v_mfma_f32_16x16x32_bf16 v[44:47], a[128:131], a[80:83], v[88:91]
    v_exp_f32 v34, v34
    v_mfma_f32_16x16x32_bf16 v[44:47], a[132:135], a[84:87], v[44:47]
    ds_read_b128 a[124:127], v4 offset:768
    ds_read_b128 a[128:131], v4 offset:1024
    v_mfma_f32_16x16x32_bf16 v[44:47], a[136:139], a[88:91], v[44:47]
    v_exp_f32 v35, v35
    v_mfma_f32_16x16x32_bf16 v[44:47], a[140:143], a[92:95], v[44:47]
    ds_read_b128 a[132:135], v4 offset:1280
    v_cvt_pk_bf16_f32 v65, v34, v35
    v_mfma_f32_16x16x32_bf16 a[176:179], a[196:199], v[56:59], a[176:179]
    v_exp_f32 v36, v36
    v_mfma_f32_16x16x32_bf16 a[180:183], a[196:199], v[60:63], a[180:183]
    s_waitcnt lgkmcnt(4)
    ds_read_b128 a[136:139], v4 offset:1536
    ds_read_b128 a[140:143], v4 offset:1792
    v_mfma_f32_16x16x32_bf16 v[96:99], a[144:147], v[56:59], v[96:99]
    v_exp_f32 v37, v37
    v_mfma_f32_16x16x32_bf16 v[128:131], a[144:147], v[60:63], v[128:131]
    v_cvt_pk_bf16_f32 v66, v36, v37
    v_mfma_f32_16x16x32_bf16 v[132:135], a[148:151], v[60:63], v[132:135]
    v_exp_f32 v38, v38
    v_mfma_f32_16x16x32_bf16 v[100:103], a[148:151], v[56:59], v[100:103]
    buffer_load_dwordx4 v1, s[12:15], s37 offen nt lds
    v_mfma_f32_16x16x32_bf16 v[104:107], a[152:155], v[56:59], v[104:107]
    v_exp_f32 v39, v39
    v_mfma_f32_16x16x32_bf16 v[136:139], a[152:155], v[60:63], v[136:139]
    v_cvt_pk_bf16_f32 v67, v38, v39
    v_mfma_f32_16x16x32_bf16 v[140:143], a[156:159], v[60:63], v[140:143]
    buffer_load_dwordx4 v1, s[12:15], s37 offen offset:1024 nt lds
    v_mfma_f32_16x16x32_bf16 v[108:111], a[156:159], v[56:59], v[108:111]
    s_add_u32 s36, s36, 2176
    v_exp_f32 v40, v40
    v_mfma_f32_16x16x32_bf16 v[112:115], a[160:163], v[56:59], v[112:115]
    s_add_u32 s37, s37, 2048
    v_mfma_f32_16x16x32_bf16 v[144:147], a[160:163], v[60:63], v[144:147]
    s_sub_u32 s33, s33, 1
    v_exp_f32 v41, v41
    v_mfma_f32_16x16x32_bf16 v[148:151], a[164:167], v[60:63], v[148:151]
    s_add_u32 m0, s30, s32
    v_cvt_pk_bf16_f32 v68, v40, v41
    v_mfma_f32_16x16x32_bf16 v[116:119], a[164:167], v[56:59], v[116:119]
    s_add_u32 s30, s30, 16512
    v_exp_f32 v42, v42
    v_mfma_f32_16x16x32_bf16 v[120:123], a[168:171], v[56:59], v[120:123]
    s_cmp_eq_u32 s30, 82560
    v_mfma_f32_16x16x32_bf16 v[152:155], a[168:171], v[60:63], v[152:155]
    s_cselect_b32 s30, 0, s30
    v_exp_f32 v43, v43
    v_mfma_f32_16x16x32_bf16 v[156:159], a[172:175], v[60:63], v[156:159]
    v_cvt_pk_bf16_f32 v69, v42, v43
    v_mfma_f32_16x16x32_bf16 v[124:127], a[172:175], v[56:59], v[124:127]
    v_exp_f32 v44, v44
    v_mfma_f32_16x16x32_bf16 v[16:19], a[112:115], a[32:35], v[76:79]
    v_add_u32 v5, s30, v3
    v_mfma_f32_16x16x32_bf16 v[16:19], a[116:119], a[36:39], v[16:19]
    s_waitcnt lgkmcnt(0)
    v_exp_f32 v45, v45
    v_mfma_f32_16x16x32_bf16 v[16:19], a[120:123], a[40:43], v[16:19]
    v_cvt_pk_bf16_f32 v70, v44, v45
    v_mfma_f32_16x16x32_bf16 v[16:19], a[124:127], a[44:47], v[16:19]
    v_exp_f32 v46, v46
    v_mfma_f32_16x16x32_bf16 v[20:23], a[128:131], a[32:35], v[76:79]
    v_add_u32 v4, s30, v2
    v_mfma_f32_16x16x32_bf16 v[20:23], a[132:135], a[36:39], v[20:23]
    v_exp_f32 v47, v47
    v_mfma_f32_16x16x32_bf16 v[20:23], a[136:139], a[40:43], v[20:23]
    s_cmp_ge_u32 s33, 10
    v_cvt_pk_bf16_f32 v71, v46, v47
    v_mfma_f32_16x16x32_bf16 v[20:23], a[140:143], a[44:47], v[20:23]
    s_branch L_N0
L_end:
    s_endpgm
L_redo:
    s_mov_b64 vcc, -1
    s_mov_b32 s34, 1
    s_waitcnt vmcnt(0) lgkmcnt(0)
    s_barrier
    s_branch L_start
    .p2align 12
L_pa1:
    s_branch L_wa
L_pb1:
    s_branch L_wb0
L_pg1:
L_N0:
    v_mfma_f32_16x16x32_bf16 v[24:27], a[112:115], a[48:51], v[80:83]
    v_exp_f32 v16, v16
    v_mfma_f32_16x16x32_bf16 v[24:27], a[116:119], a[52:55], v[24:27]
    v_mfma_f32_16x16x32_bf16 v[24:27], a[120:123], a[56:59], v[24:27]
    v_exp_f32 v17, v17
    v_mfma_f32_16x16x32_bf16 v[24:27], a[124:127], a[60:63], v[24:27]
    v_cvt_pk_bf16_f32 v56, v16, v17
    v_mfma_f32_16x16x32_bf16 v[28:31], a[128:131], a[48:51], v[80:83]
    v_exp_f32 v18, v18
    v_mfma_f32_16x16x32_bf16 v[28:31], a[132:135], a[52:55], v[28:31]
    v_mfma_f32_16x16x32_bf16 v[28:31], a[136:139], a[56:59], v[28:31]
    v_exp_f32 v19, v19
    v_mfma_f32_16x16x32_bf16 v[28:31], a[140:143], a[60:63], v[28:31]
    v_cvt_pk_bf16_f32 v57, v18, v19
    v_mfma_f32_16x16x32_bf16 a[184:187], a[196:199], v[64:67], a[184:187]
    v_exp_f32 v20, v20
    v_mfma_f32_16x16x32_bf16 a[188:191], a[196:199], v[68:71], a[188:191]
    s_waitcnt vmcnt(20)
    s_barrier
    v_mfma_f32_16x16x32_bf16 v[160:163], a[144:147], v[64:67], v[160:163]
    v_exp_f32 v21, v21
    v_mfma_f32_16x16x32_bf16 v[192:195], a[144:147], v[68:71], v[192:195]
    ds_read_b64_tr_b16 a[144:145], v5 offset:2048
    v_cvt_pk_bf16_f32 v58, v20, v21
    v_mfma_f32_16x16x32_bf16 v[196:199], a[148:151], v[68:71], v[196:199]
    v_exp_f32 v22, v22
    v_mfma_f32_16x16x32_bf16 v[164:167], a[148:151], v[64:67], v[164:167]
    buffer_load_dwordx4 v1, s[16:19], s64 offen nt lds
    v_mfma_f32_16x16x32_bf16 v[168:171], a[152:155], v[64:67], v[168:171]
    v_exp_f32 v23, v23
    v_mfma_f32_16x16x32_bf16 v[200:203], a[152:155], v[68:71], v[200:203]
    ds_read_b64_tr_b16 a[146:147], v5 offset:3072
    v_cvt_pk_bf16_f32 v59, v22, v23
    v_mfma_f32_16x16x32_bf16 v[204:207], a[156:159], v[68:71], v[204:207]
    buffer_load_dwordx4 v1, s[16:19], s64 offen offset:1024 nt lds
    v_mfma_f32_16x16x32_bf16 v[172:175], a[156:159], v[64:67], v[172:175]
    v_exp_f32 v24, v24
    v_mfma_f32_16x16x32_bf16 v[176:179], a[160:163], v[64:67], v[176:179]
    buffer_load_dwordx4 v1, s[20:23], s65 offen offset:2048 nt lds
    v_mfma_f32_16x16x32_bf16 v[208:211], a[160:163], v[68:71], v[208:211]
    v_exp_f32 v25, v25
    v_mfma_f32_16x16x32_bf16 v[212:215], a[164:167], v[68:71], v[212:215]
    ds_read_b64_tr_b16 a[148:149], v5 offset:2080
    v_cvt_pk_bf16_f32 v60, v24, v25
    v_mfma_f32_16x16x32_bf16 v[180:183], a[164:167], v[64:67], v[180:183]
    v_exp_f32 v26, v26
    v_mfma_f32_16x16x32_bf16 v[184:187], a[168:171], v[64:67], v[184:187]
    buffer_load_dwordx4 v1, s[20:23], s65 offen offset:3072 nt lds
    v_mfma_f32_16x16x32_bf16 v[216:219], a[168:171], v[68:71], v[216:219]
    s_mov_b32 s65, s64
    v_exp_f32 v27, v27
    v_mfma_f32_16x16x32_bf16 v[220:223], a[172:175], v[68:71], v[220:223]
    s_add_u32 s31, s31, 8192
    ds_read_b64_tr_b16 a[150:151], v5 offset:3104
    v_cvt_pk_bf16_f32 v61, v26, v27
    v_mfma_f32_16x16x32_bf16 v[188:191], a[172:175], v[64:67], v[188:191]
    s_or_b32 s31, s31, s67
    v_exp_f32 v28, v28
    v_mfma_f32_16x16x32_bf16 v[48:51], a[112:115], a[96:99], v[92:95]
    s_xor_b32 s64, s31, s66
    ds_read_b64_tr_b16 a[152:153], v5 offset:2304
    ds_read_b64_tr_b16 a[154:155], v5 offset:3328
    v_mfma_f32_16x16x32_bf16 v[48:51], a[116:119], a[100:103], v[48:51]
    s_mov_b32 m0, s36
    v_exp_f32 v29, v29
    v_mfma_f32_16x16x32_bf16 v[48:51], a[120:123], a[104:107], v[48:51]
    ds_read_b64_tr_b16 a[156:157], v5 offset:2336
    v_cvt_pk_bf16_f32 v62, v28, v29
    v_mfma_f32_16x16x32_bf16 v[48:51], a[124:127], a[108:111], v[48:51]
    v_exp_f32 v30, v30
    v_mfma_f32_16x16x32_bf16 v[52:55], a[128:131], a[96:99], v[92:95]
    ds_read_b64_tr_b16 a[158:159], v5 offset:3360
    ds_read_b64_tr_b16 a[160:161], v5 offset:2560
    v_mfma_f32_16x16x32_bf16 v[52:55], a[132:135], a[100:103], v[52:55]
    v_exp_f32 v31, v31
    v_mfma_f32_16x16x32_bf16 v[52:55], a[136:139], a[104:107], v[52:55]
    ds_read_b64_tr_b16 a[162:163], v5 offset:3584
    v_cvt_pk_bf16_f32 v63, v30, v31
    v_mfma_f32_16x16x32_bf16 v[52:55], a[140:143], a[108:111], v[52:55]
    ds_read_b64_tr_b16 a[164:165], v5 offset:2592
    ds_read_b64_tr_b16 a[166:167], v5 offset:3616
    v_mfma_f32_16x16x32_bf16 v[32:35], a[112:115], a[64:67], v[84:87]
    v_exp_f32 v48, v48
    v_mfma_f32_16x16x32_bf16 v[32:35], a[116:119], a[68:71], v[32:35]
    ds_read_b64_tr_b16 a[168:169], v5 offset:2816
    ds_read_b64_tr_b16 a[170:171], v5 offset:3840
    v_mfma_f32_16x16x32_bf16 v[32:35], a[120:123], a[72:75], v[32:35]
    v_exp_f32 v49, v49
    v_mfma_f32_16x16x32_bf16 v[32:35], a[124:127], a[76:79], v[32:35]
    ds_read_b64_tr_b16 a[172:173], v5 offset:2848
    v_cvt_pk_bf16_f32 v72, v48, v49
    v_mfma_f32_16x16x32_bf16 v[36:39], a[128:131], a[64:67], v[84:87]
    v_exp_f32 v50, v50
    v_mfma_f32_16x16x32_bf16 v[36:39], a[132:135], a[68:71], v[36:39]
    ds_read_b64_tr_b16 a[174:175], v5 offset:3872
    v_mfma_f32_16x16x32_bf16 v[36:39], a[136:139], a[72:75], v[36:39]
    v_exp_f32 v51, v51
    v_mfma_f32_16x16x32_bf16 v[36:39], a[140:143], a[76:79], v[36:39]
    v_cvt_pk_bf16_f32 v73, v50, v51
    v_mfma_f32_16x16x32_bf16 a[176:179], a[196:199], v[56:59], a[176:179]
    v_exp_f32 v52, v52
    v_mfma_f32_16x16x32_bf16 a[180:183], a[196:199], v[60:63], a[180:183]
    s_waitcnt lgkmcnt(2)
    buffer_load_dwordx4 v1, s[12:15], s37 offen nt lds
    v_mfma_f32_16x16x32_bf16 v[96:99], a[144:147], v[56:59], v[96:99]
    v_exp_f32 v53, v53
    v_mfma_f32_16x16x32_bf16 v[128:131], a[144:147], v[60:63], v[128:131]
    v_cvt_pk_bf16_f32 v74, v52, v53
    v_mfma_f32_16x16x32_bf16 v[132:135], a[148:151], v[60:63], v[132:135]
    v_exp_f32 v54, v54
    v_mfma_f32_16x16x32_bf16 v[100:103], a[148:151], v[56:59], v[100:103]
    buffer_load_dwordx4 v1, s[12:15], s37 offen offset:1024 nt lds
    v_mfma_f32_16x16x32_bf16 v[104:107], a[152:155], v[56:59], v[104:107]
    s_add_u32 s36, s36, 2176
    v_exp_f32 v55, v55
    v_mfma_f32_16x16x32_bf16 v[136:139], a[152:155], v[60:63], v[136:139]
    s_add_u32 s37, s37, 2048
    v_cvt_pk_bf16_f32 v75, v54, v55
    v_mfma_f32_16x16x32_bf16 v[140:143], a[156:159], v[60:63], v[140:143]
    s_sub_u32 s33, s33, 1
    v_mfma_f32_16x16x32_bf16 v[108:111], a[156:159], v[56:59], v[108:111]
    s_add_u32 m0, s30, s32
    v_exp_f32 v32, v32
    v_mfma_f32_16x16x32_bf16 v[112:115], a[160:163], v[56:59], v[112:115]
    s_add_u32 s30, s30, 16512
    v_mfma_f32_16x16x32_bf16 v[144:147], a[160:163], v[60:63], v[144:147]
    s_cmp_eq_u32 s30, 82560
    v_exp_f32 v33, v33
    v_mfma_f32_16x16x32_bf16 v[148:151], a[164:167], v[60:63], v[148:151]
    s_cselect_b32 s30, 0, s30
    v_cvt_pk_bf16_f32 v64, v32, v33
    v_mfma_f32_16x16x32_bf16 v[116:119], a[164:167], v[56:59], v[116:119]
    v_exp_f32 v34, v34
    v_mfma_f32_16x16x32_bf16 v[120:123], a[168:171], v[56:59], v[120:123]
    v_mfma_f32_16x16x32_bf16 v[152:155], a[168:171], v[60:63], v[152:155]
    s_waitcnt lgkmcnt(0)
    v_exp_f32 v35, v35
    v_mfma_f32_16x16x32_bf16 v[156:159], a[172:175], v[60:63], v[156:159]
    v_cvt_pk_bf16_f32 v65, v34, v35
    v_mfma_f32_16x16x32_bf16 v[124:127], a[172:175], v[56:59], v[124:127]
    v_exp_f32 v36, v36
    v_mfma_f32_16x16x32_bf16 v[40:43], a[112:115], a[80:83], v[88:91]
    ds_read_b128 a[112:115], v4 offset:0
    v_add_u32 v5, s30, v3
    v_mfma_f32_16x16x32_bf16 v[40:43], a[116:119], a[84:87], v[40:43]
    v_exp_f32 v37, v37
    v_mfma_f32_16x16x32_bf16 v[40:43], a[120:123], a[88:91], v[40:43]
    ds_read_b128 a[116:119], v4 offset:256
    v_cvt_pk_bf16_f32 v66, v36, v37
    v_mfma_f32_16x16x32_bf16 v[40:43], a[124:127], a[92:95], v[40:43]
    v_exp_f32 v38, v38
    v_mfma_f32_16x16x32_bf16 v[44:47], a[128:131], a[80:83], v[88:91]
    ds_read_b128 a[120:123], v4 offset:512
    ds_read_b128 a[124:127], v4 offset:768
    v_mfma_f32_16x16x32_bf16 v[44:47], a[132:135], a[84:87], v[44:47]
    v_exp_f32 v39, v39
    v_mfma_f32_16x16x32_bf16 v[44:47], a[136:139], a[88:91], v[44:47]
    ds_read_b128 a[128:131], v4 offset:1024
    v_cvt_pk_bf16_f32 v67, v38, v39
    v_mfma_f32_16x16x32_bf16 v[44:47], a[140:143], a[92:95], v[44:47]
    ds_read_b128 a[132:135], v4 offset:1280
    ds_read_b128 a[136:139], v4 offset:1536
    v_mfma_f32_16x16x32_bf16 a[192:195], a[196:199], v[72:75], a[192:195]
    v_exp_f32 v40, v40
    v_mfma_f32_16x16x32_bf16 a[0:3], a[144:147], v[72:75], a[0:3]
    ds_read_b128 a[140:143], v4 offset:1792
    v_add_u32 v4, s30, v2
    v_mfma_f32_16x16x32_bf16 a[4:7], a[148:151], v[72:75], a[4:7]
    v_exp_f32 v41, v41
    v_mfma_f32_16x16x32_bf16 a[8:11], a[152:155], v[72:75], a[8:11]
    v_cvt_pk_bf16_f32 v68, v40, v41
    v_mfma_f32_16x16x32_bf16 a[12:15], a[156:159], v[72:75], a[12:15]
    v_exp_f32 v42, v42
    v_mfma_f32_16x16x32_bf16 a[16:19], a[160:163], v[72:75], a[16:19]
    v_mfma_f32_16x16x32_bf16 a[20:23], a[164:167], v[72:75], a[20:23]
    v_exp_f32 v43, v43
    v_mfma_f32_16x16x32_bf16 a[24:27], a[168:171], v[72:75], a[24:27]
    v_cvt_pk_bf16_f32 v69, v42, v43
    v_mfma_f32_16x16x32_bf16 a[28:31], a[172:175], v[72:75], a[28:31]
    s_waitcnt lgkmcnt(0)
    v_exp_f32 v44, v44
    v_mfma_f32_16x16x32_bf16 v[16:19], a[112:115], a[32:35], v[76:79]
    v_mfma_f32_16x16x32_bf16 v[16:19], a[116:119], a[36:39], v[16:19]
    v_exp_f32 v45, v45
    v_mfma_f32_16x16x32_bf16 v[16:19], a[120:123], a[40:43], v[16:19]
    v_cvt_pk_bf16_f32 v70, v44, v45
    v_mfma_f32_16x16x32_bf16 v[16:19], a[124:127], a[44:47], v[16:19]
    v_exp_f32 v46, v46
    v_mfma_f32_16x16x32_bf16 v[20:23], a[128:131], a[32:35], v[76:79]
    v_mfma_f32_16x16x32_bf16 v[20:23], a[132:135], a[36:39], v[20:23]
    v_exp_f32 v47, v47
    v_mfma_f32_16x16x32_bf16 v[20:23], a[136:139], a[40:43], v[20:23]
    v_cvt_pk_bf16_f32 v71, v46, v47
    v_mfma_f32_16x16x32_bf16 v[20:23], a[140:143], a[44:47], v[20:23]
L_N85:
    v_mfma_f32_16x16x32_bf16 v[24:27], a[112:115], a[48:51], v[80:83]
    v_exp_f32 v16, v16
    v_mfma_f32_16x16x32_bf16 v[24:27], a[116:119], a[52:55], v[24:27]
    s_waitcnt vmcnt(20)
    s_barrier
    v_mfma_f32_16x16x32_bf16 v[24:27], a[120:123], a[56:59], v[24:27]
    v_exp_f32 v17, v17
    v_mfma_f32_16x16x32_bf16 v[24:27], a[124:127], a[60:63], v[24:27]
    v_cvt_pk_bf16_f32 v56, v16, v17
    v_mfma_f32_16x16x32_bf16 v[28:31], a[128:131], a[48:51], v[80:83]
    v_exp_f32 v18, v18
    v_mfma_f32_16x16x32_bf16 v[28:31], a[132:135], a[52:55], v[28:31]
    buffer_load_dwordx4 v1, s[16:19], s64 offen nt lds
    v_mfma_f32_16x16x32_bf16 v[28:31], a[136:139], a[56:59], v[28:31]
    v_exp_f32 v19, v19
    v_mfma_f32_16x16x32_bf16 v[28:31], a[140:143], a[60:63], v[28:31]
    v_cvt_pk_bf16_f32 v57, v18, v19
    v_mfma_f32_16x16x32_bf16 a[184:187], a[196:199], v[64:67], a[184:187]
    v_exp_f32 v20, v20
    v_mfma_f32_16x16x32_bf16 a[188:191], a[196:199], v[68:71], a[188:191]
    buffer_load_dwordx4 v1, s[16:19], s64 offen offset:1024 nt lds
    v_mfma_f32_16x16x32_bf16 v[160:163], a[144:147], v[64:67], v[160:163]
    v_exp_f32 v21, v21
    v_mfma_f32_16x16x32_bf16 v[192:195], a[144:147], v[68:71], v[192:195]
    ds_read_b64_tr_b16 a[144:145], v5 offset:2048
    v_cvt_pk_bf16_f32 v58, v20, v21
    v_mfma_f32_16x16x32_bf16 v[196:199], a[148:151], v[68:71], v[196:199]
    v_exp_f32 v22, v22
    v_mfma_f32_16x16x32_bf16 v[164:167], a[148:151], v[64:67], v[164:167]
    buffer_load_dwordx4 v1, s[20:23], s65 offen offset:2048 nt lds
    v_mfma_f32_16x16x32_bf16 v[168:171], a[152:155], v[64:67], v[168:171]
    v_exp_f32 v23, v23
    v_mfma_f32_16x16x32_bf16 v[200:203], a[152:155], v[68:71], v[200:203]
    ds_read_b64_tr_b16 a[146:147], v5 offset:3072
    v_cvt_pk_bf16_f32 v59, v22, v23
    v_mfma_f32_16x16x32_bf16 v[204:207], a[156:159], v[68:71], v[204:207]
    buffer_load_dwordx4 v1, s[20:23], s65 offen offset:3072 nt lds
    v_mfma_f32_16x16x32_bf16 v[172:175], a[156:159], v[64:67], v[172:175]
    s_mov_b32 s65, s64
    v_exp_f32 v24, v24
    v_mfma_f32_16x16x32_bf16 v[176:179], a[160:163], v[64:67], v[176:179]
    s_add_u32 s31, s31, 8192
    ds_read_b64_tr_b16 a[148:149], v5 offset:2080
    ds_read_b64_tr_b16 a[150:151], v5 offset:3104
    v_mfma_f32_16x16x32_bf16 v[208:211], a[160:163], v[68:71], v[208:211]
    s_or_b32 s31, s31, s67
    v_exp_f32 v25, v25
    v_mfma_f32_16x16x32_bf16 v[212:215], a[164:167], v[68:71], v[212:215]
    s_xor_b32 s64, s31, s66
    ds_read_b64_tr_b16 a[152:153], v5 offset:2304
    v_cvt_pk_bf16_f32 v60, v24, v25
    v_mfma_f32_16x16x32_bf16 v[180:183], a[164:167], v[64:67], v[180:183]
    s_mov_b32 m0, s36
    v_exp_f32 v26, v26
    v_mfma_f32_16x16x32_bf16 v[184:187], a[168:171], v[64:67], v[184:187]
    ds_read_b64_tr_b16 a[154:155], v5 offset:3328
    ds_read_b64_tr_b16 a[156:157], v5 offset:2336
    v_mfma_f32_16x16x32_bf16 v[216:219], a[168:171], v[68:71], v[216:219]
    v_exp_f32 v27, v27
    v_mfma_f32_16x16x32_bf16 v[220:223], a[172:175], v[68:71], v[220:223]
    ds_read_b64_tr_b16 a[158:159], v5 offset:3360
    v_cvt_pk_bf16_f32 v61, v26, v27
    v_mfma_f32_16x16x32_bf16 v[188:191], a[172:175], v[64:67], v[188:191]
    v_exp_f32 v28, v28
    v_mfma_f32_16x16x32_bf16 v[32:35], a[112:115], a[64:67], v[84:87]
    ds_read_b64_tr_b16 a[160:161], v5 offset:2560
    ds_read_b64_tr_b16 a[162:163], v5 offset:3584
    v_mfma_f32_16x16x32_bf16 v[32:35], a[116:119], a[68:71], v[32:35]
    v_exp_f32 v29, v29
    v_mfma_f32_16x16x32_bf16 v[32:35], a[120:123], a[72:75], v[32:35]
    ds_read_b64_tr_b16 a[164:165], v5 offset:2592
    v_cvt_pk_bf16_f32 v62, v28, v29
    v_mfma_f32_16x16x32_bf16 v[32:35], a[124:127], a[76:79], v[32:35]
    v_exp_f32 v30, v30
    v_mfma_f32_16x16x32_bf16 v[36:39], a[128:131], a[64:67], v[84:87]
    ds_read_b64_tr_b16 a[166:167], v5 offset:3616
    ds_read_b64_tr_b16 a[168:169], v5 offset:2816
    v_mfma_f32_16x16x32_bf16 v[36:39], a[132:135], a[68:71], v[36:39]
    v_exp_f32 v31, v31
    v_mfma_f32_16x16x32_bf16 v[36:39], a[136:139], a[72:75], v[36:39]
    ds_read_b64_tr_b16 a[170:171], v5 offset:3840
    v_cvt_pk_bf16_f32 v63, v30, v31
    v_mfma_f32_16x16x32_bf16 v[36:39], a[140:143], a[76:79], v[36:39]
    ds_read_b64_tr_b16 a[172:173], v5 offset:2848
    ds_read_b64_tr_b16 a[174:175], v5 offset:3872
    v_mfma_f32_16x16x32_bf16 v[40:43], a[112:115], a[80:83], v[88:91]
    v_exp_f32 v32, v32
    v_mfma_f32_16x16x32_bf16 v[40:43], a[116:119], a[84:87], v[40:43]
    ds_read_b128 a[112:115], v4 offset:0
    ds_read_b128 a[116:119], v4 offset:256
    v_mfma_f32_16x16x32_bf16 v[40:43], a[120:123], a[88:91], v[40:43]
    v_exp_f32 v33, v33
    v_mfma_f32_16x16x32_bf16 v[40:43], a[124:127], a[92:95], v[40:43]
    ds_read_b128 a[120:123], v4 offset:512
    v_cvt_pk_bf16_f32 v64, v32, v33
    v_mfma_f32_16x16x32_bf16 v[44:47], a[128:131], a[80:83], v[88:91]
    v_exp_f32 v34, v34
    v_mfma_f32_16x16x32_bf16 v[44:47], a[132:135], a[84:87], v[44:47]
    ds_read_b128 a[124:127], v4 offset:768
    ds_read_b128 a[128:131], v4 offset:1024
    v_mfma_f32_16x16x32_bf16 v[44:47], a[136:139], a[88:91], v[44:47]
    v_exp_f32 v35, v35
    v_mfma_f32_16x16x32_bf16 v[44:47], a[140:143], a[92:95], v[44:47]
    ds_read_b128 a[132:135], v4 offset:1280
    v_cvt_pk_bf16_f32 v65, v34, v35
    v_mfma_f32_16x16x32_bf16 a[176:179], a[196:199], v[56:59], a[176:179]
    v_exp_f32 v36, v36
    v_mfma_f32_16x16x32_bf16 a[180:183], a[196:199], v[60:63], a[180:183]
    s_waitcnt lgkmcnt(4)
    ds_read_b128 a[136:139], v4 offset:1536
    ds_read_b128 a[140:143], v4 offset:1792
    v_mfma_f32_16x16x32_bf16 v[96:99], a[144:147], v[56:59], v[96:99]
    v_exp_f32 v37, v37
    v_mfma_f32_16x16x32_bf16 v[128:131], a[144:147], v[60:63], v[128:131]
    v_cvt_pk_bf16_f32 v66, v36, v37
    v_mfma_f32_16x16x32_bf16 v[132:135], a[148:151], v[60:63], v[132:135]
    v_exp_f32 v38, v38
    v_mfma_f32_16x16x32_bf16 v[100:103], a[148:151], v[56:59], v[100:103]
    buffer_load_dwordx4 v1, s[12:15], s37 offen nt lds
    v_mfma_f32_16x16x32_bf16 v[104:107], a[152:155], v[56:59], v[104:107]
    v_exp_f32 v39, v39
    v_mfma_f32_16x16x32_bf16 v[136:139], a[152:155], v[60:63], v[136:139]
    v_cvt_pk_bf16_f32 v67, v38, v39
    v_mfma_f32_16x16x32_bf16 v[140:143], a[156:159], v[60:63], v[140:143]
    buffer_load_dwordx4 v1, s[12:15], s37 offen offset:1024 nt lds
    v_mfma_f32_16x16x32_bf16 v[108:111], a[156:159], v[56:59], v[108:111]
    s_add_u32 s36, s36, 2176
    v_exp_f32 v40, v40
    v_mfma_f32_16x16x32_bf16 v[112:115], a[160:163], v[56:59], v[112:115]
    s_add_u32 s37, s37, 2048
    v_mfma_f32_16x16x32_bf16 v[144:147], a[160:163], v[60:63], v[144:147]
    s_sub_u32 s33, s33, 1
    v_exp_f32 v41, v41
    v_mfma_f32_16x16x32_bf16 v[148:151], a[164:167], v[60:63], v[148:151]
    s_add_u32 m0, s30, s32
    v_cvt_pk_bf16_f32 v68, v40, v41
    v_mfma_f32_16x16x32_bf16 v[116:119], a[164:167], v[56:59], v[116:119]
    s_add_u32 s30, s30, 16512
    v_exp_f32 v42, v42
    v_mfma_f32_16x16x32_bf16 v[120:123], a[168:171], v[56:59], v[120:123]
    s_cmp_eq_u32 s30, 82560
    v_mfma_f32_16x16x32_bf16 v[152:155], a[168:171], v[60:63], v[152:155]
    s_cselect_b32 s30, 0, s30
    v_exp_f32 v43, v43
    v_mfma_f32_16x16x32_bf16 v[156:159], a[172:175], v[60:63], v[156:159]
    v_cvt_pk_bf16_f32 v69, v42, v43
    v_mfma_f32_16x16x32_bf16 v[124:127], a[172:175], v[56:59], v[124:127]
    v_exp_f32 v44, v44
    v_mfma_f32_16x16x32_bf16 v[16:19], a[112:115], a[32:35], v[76:79]
    v_add_u32 v5, s30, v3
    v_mfma_f32_16x16x32_bf16 v[16:19], a[116:119], a[36:39], v[16:19]
    s_waitcnt lgkmcnt(0)
    v_exp_f32 v45, v45
    v_mfma_f32_16x16x32_bf16 v[16:19], a[120:123], a[40:43], v[16:19]
    v_cvt_pk_bf16_f32 v70, v44, v45
    v_mfma_f32_16x16x32_bf16 v[16:19], a[124:127], a[44:47], v[16:19]
    v_exp_f32 v46, v46
    v_mfma_f32_16x16x32_bf16 v[20:23], a[128:131], a[32:35], v[76:79]
    v_add_u32 v4, s30, v2
    v_mfma_f32_16x16x32_bf16 v[20:23], a[132:135], a[36:39], v[20:23]
    v_exp_f32 v47, v47
    v_mfma_f32_16x16x32_bf16 v[20:23], a[136:139], a[40:43], v[20:23]
    s_cmp_ge_u32 s33, 10
    v_cvt_pk_bf16_f32 v71, v46, v47
    v_mfma_f32_16x16x32_bf16 v[20:23], a[140:143], a[44:47], v[20:23]
    s_cbranch_scc1 L_N0
    s_branch L_A0
    .p2align 12
L_pa2:
    s_branch L_wa
L_pb2:
    s_branch L_wb0
L_pg2:
L_A0:
    v_mfma_f32_16x16x32_bf16 v[24:27], a[112:115], a[48:51], v[80:83]
    v_exp_f32 v16, v16
    v_mfma_f32_16x16x32_bf16 v[24:27], a[116:119], a[52:55], v[24:27]
    v_mfma_f32_16x16x32_bf16 v[24:27], a[120:123], a[56:59], v[24:27]
    v_exp_f32 v17, v17
    v_mfma_f32_16x16x32_bf16 v[24:27], a[124:127], a[60:63], v[24:27]
    v_cvt_pk_bf16_f32 v56, v16, v17
    v_mfma_f32_16x16x32_bf16 v[28:31], a[128:131], a[48:51], v[80:83]
    v_exp_f32 v18, v18
    v_mfma_f32_16x16x32_bf16 v[28:31], a[132:135], a[52:55], v[28:31]
    v_mfma_f32_16x16x32_bf16 v[28:31], a[136:139], a[56:59], v[28:31]
    v_exp_f32 v19, v19
    v_mfma_f32_16x16x32_bf16 v[28:31], a[140:143], a[60:63], v[28:31]
    v_cvt_pk_bf16_f32 v57, v18, v19
    v_mfma_f32_16x16x32_bf16 a[184:187], a[196:199], v[64:67], a[184:187]
    v_exp_f32 v20, v20
    v_mfma_f32_16x16x32_bf16 a[188:191], a[196:199], v[68:71], a[188:191]
    s_waitcnt vmcnt(20) lgkmcnt(0)
    s_barrier
    v_mfma_f32_16x16x32_bf16 v[160:163], a[144:147], v[64:67], v[160:163]
    s_add_u32 s38, s38, 2176
    v_exp_f32 v21, v21
    v_mfma_f32_16x16x32_bf16 v[192:195], a[144:147], v[68:71], v[192:195]
    s_cmp_lt_u32 s38, 19584
    ds_read_b64_tr_b16 a[144:145], v5 offset:2048
    v_cvt_pk_bf16_f32 v58, v20, v21
    v_mfma_f32_16x16x32_bf16 v[196:199], a[148:151], v[68:71], v[196:199]
    s_cselect_b32 s42, s38, s39
    v_exp_f32 v22, v22
    v_add_u32 v10, s42, v11
    v_mfma_f32_16x16x32_bf16 v[164:167], a[148:151], v[64:67], v[164:167]
    buffer_load_dwordx4 v1, s[16:19], s64 offen nt lds
    v_mfma_f32_16x16x32_bf16 v[168:171], a[152:155], v[64:67], v[168:171]
    v_exp_f32 v23, v23
    v_mfma_f32_16x16x32_bf16 v[200:203], a[152:155], v[68:71], v[200:203]
    ds_read_b128 v[240:243], v10 offset:0
    v_cvt_pk_bf16_f32 v59, v22, v23
    v_mfma_f32_16x16x32_bf16 v[204:207], a[156:159], v[68:71], v[204:207]
    buffer_load_dwordx4 v1, s[16:19], s64 offen offset:1024 nt lds
    v_mfma_f32_16x16x32_bf16 v[172:175], a[156:159], v[64:67], v[172:175]
    v_exp_f32 v24, v24
    v_mfma_f32_16x16x32_bf16 v[176:179], a[160:163], v[64:67], v[176:179]
    buffer_load_dwordx4 v1, s[20:23], s65 offen offset:2048 nt lds
    v_mfma_f32_16x16x32_bf16 v[208:211], a[160:163], v[68:71], v[208:211]
    v_exp_f32 v25, v25
    v_mfma_f32_16x16x32_bf16 v[212:215], a[164:167], v[68:71], v[212:215]
    ds_read_b128 v[244:247], v10 offset:1024
    v_cvt_pk_bf16_f32 v60, v24, v25
    v_mfma_f32_16x16x32_bf16 v[180:183], a[164:167], v[64:67], v[180:183]
    v_exp_f32 v26, v26
    v_mfma_f32_16x16x32_bf16 v[184:187], a[168:171], v[64:67], v[184:187]
    buffer_load_dwordx4 v1, s[20:23], s65 offen offset:3072 nt lds
    v_mfma_f32_16x16x32_bf16 v[216:219], a[168:171], v[68:71], v[216:219]
    s_mov_b32 s65, s64
    v_exp_f32 v27, v27
    v_mfma_f32_16x16x32_bf16 v[220:223], a[172:175], v[68:71], v[220:223]
    s_add_u32 s31, s31, 8192
    ds_read_b64_tr_b16 a[146:147], v5 offset:3072
    v_cvt_pk_bf16_f32 v61, v26, v27
    v_mfma_f32_16x16x32_bf16 v[188:191], a[172:175], v[64:67], v[188:191]
    s_or_b32 s31, s31, s67
    v_exp_f32 v28, v28
    v_mfma_f32_16x16x32_bf16 v[48:51], a[112:115], a[96:99], v[92:95]
    s_xor_b32 s64, s31, s66
    ds_read_b64_tr_b16 a[148:149], v5 offset:2080
    ds_read_b64_tr_b16 a[150:151], v5 offset:3104
    v_mfma_f32_16x16x32_bf16 v[48:51], a[116:119], a[100:103], v[48:51]
    s_cmp_ge_u32 s33, 6
    v_exp_f32 v29, v29
    v_mfma_f32_16x16x32_bf16 v[48:51], a[120:123], a[104:107], v[48:51]
    s_cselect_b32 m0, s36, 160896
    ds_read_b64_tr_b16 a[152:153], v5 offset:2304
    v_cvt_pk_bf16_f32 v62, v28, v29
    v_mfma_f32_16x16x32_bf16 v[48:51], a[124:127], a[108:111], v[48:51]
    s_cselect_b32 s41, s37, s35
    v_exp_f32 v30, v30
    v_mfma_f32_16x16x32_bf16 v[52:55], a[128:131], a[96:99], v[92:95]
    ds_read_b64_tr_b16 a[154:155], v5 offset:3328
    ds_read_b64_tr_b16 a[156:157], v5 offset:2336
    v_mfma_f32_16x16x32_bf16 v[52:55], a[132:135], a[100:103], v[52:55]
    v_exp_f32 v31, v31
    v_mfma_f32_16x16x32_bf16 v[52:55], a[136:139], a[104:107], v[52:55]
    ds_read_b64_tr_b16 a[158:159], v5 offset:3360
    v_cvt_pk_bf16_f32 v63, v30, v31
    v_mfma_f32_16x16x32_bf16 v[52:55], a[140:143], a[108:111], v[52:55]
    ds_read_b64_tr_b16 a[160:161], v5 offset:2560
    ds_read_b64_tr_b16 a[162:163], v5 offset:3584
    v_mfma_f32_16x16x32_bf16 v[32:35], a[112:115], a[64:67], v[84:87]
    v_exp_f32 v48, v48
    v_mfma_f32_16x16x32_bf16 v[32:35], a[116:119], a[68:71], v[32:35]
    ds_read_b64_tr_b16 a[164:165], v5 offset:2592
    ds_read_b64_tr_b16 a[166:167], v5 offset:3616
    v_mfma_f32_16x16x32_bf16 v[32:35], a[120:123], a[72:75], v[32:35]
    v_exp_f32 v49, v49
    v_mfma_f32_16x16x32_bf16 v[32:35], a[124:127], a[76:79], v[32:35]
    ds_read_b64_tr_b16 a[168:169], v5 offset:2816
    v_cvt_pk_bf16_f32 v72, v48, v49
    v_mfma_f32_16x16x32_bf16 v[36:39], a[128:131], a[64:67], v[84:87]
    v_exp_f32 v50, v50
    v_mfma_f32_16x16x32_bf16 v[36:39], a[132:135], a[68:71], v[36:39]
    ds_read_b64_tr_b16 a[170:171], v5 offset:3840
    ds_read_b64_tr_b16 a[172:173], v5 offset:2848
    v_mfma_f32_16x16x32_bf16 v[36:39], a[136:139], a[72:75], v[36:39]
    v_exp_f32 v51, v51
    v_mfma_f32_16x16x32_bf16 v[36:39], a[140:143], a[76:79], v[36:39]
    ds_read_b64_tr_b16 a[174:175], v5 offset:3872
    v_cvt_pk_bf16_f32 v73, v50, v51
    v_mfma_f32_16x16x32_bf16 a[176:179], a[196:199], v[56:59], a[176:179]
    v_exp_f32 v52, v52
    v_mfma_f32_16x16x32_bf16 a[180:183], a[196:199], v[60:63], a[180:183]
    s_waitcnt lgkmcnt(4)
    buffer_load_dwordx4 v1, s[12:15], s41 offen nt lds
    v_mfma_f32_16x16x32_bf16 v[96:99], a[144:147], v[56:59], v[96:99]
    v_exp_f32 v53, v53
    v_mfma_f32_16x16x32_bf16 v[128:131], a[144:147], v[60:63], v[128:131]
    v_cvt_pk_bf16_f32 v74, v52, v53
    v_lshlrev_b32 v228, 16, v240
    v_and_b32 v229, s45, v240
    v_mul_f32 v228, s28, v228
    v_mul_f32 v229, s28, v229
    v_cvt_pk_bf16_f32 v240, v228, v229
    v_lshlrev_b32 v230, 16, v241
    v_and_b32 v231, s45, v241
    v_mfma_f32_16x16x32_bf16 v[132:135], a[148:151], v[60:63], v[132:135]
    v_exp_f32 v54, v54
    v_mfma_f32_16x16x32_bf16 v[100:103], a[148:151], v[56:59], v[100:103]
    buffer_load_dwordx4 v1, s[12:15], s41 offen offset:1024 nt lds
    v_mfma_f32_16x16x32_bf16 v[104:107], a[152:155], v[56:59], v[104:107]
    s_add_u32 s36, s36, 2176
    v_exp_f32 v55, v55
    v_mfma_f32_16x16x32_bf16 v[136:139], a[152:155], v[60:63], v[136:139]
    s_add_u32 s37, s37, 2048
    v_cvt_pk_bf16_f32 v75, v54, v55
    v_mul_f32 v230, s28, v230
    v_mul_f32 v231, s28, v231
    v_cvt_pk_bf16_f32 v241, v230, v231
    v_lshlrev_b32 v228, 16, v242
    v_and_b32 v229, s45, v242
    v_mul_f32 v228, s28, v228
    v_mul_f32 v229, s28, v229
    v_mfma_f32_16x16x32_bf16 v[140:143], a[156:159], v[60:63], v[140:143]
    s_add_u32 m0, s30, s32
    v_cvt_pk_bf16_f32 v242, v228, v229
    v_lshlrev_b32 v230, 16, v243
    v_and_b32 v231, s45, v243
    v_mul_f32 v230, s28, v230
    v_mul_f32 v231, s28, v231
    v_cvt_pk_bf16_f32 v243, v230, v231
    v_mfma_f32_16x16x32_bf16 v[108:111], a[156:159], v[56:59], v[108:111]
    s_add_u32 s30, s30, 16512
    v_exp_f32 v32, v32
    v_mfma_f32_16x16x32_bf16 v[112:115], a[160:163], v[56:59], v[112:115]
    s_cmp_eq_u32 s30, 82560
    ds_write_b128 v10, v[240:243] offset:0
    v_mfma_f32_16x16x32_bf16 v[144:147], a[160:163], v[60:63], v[144:147]
    s_cselect_b32 s30, 0, s30
    v_exp_f32 v33, v33
    v_mfma_f32_16x16x32_bf16 v[148:151], a[164:167], v[60:63], v[148:151]
    v_cvt_pk_bf16_f32 v64, v32, v33
    v_lshlrev_b32 v228, 16, v244
    v_and_b32 v229, s45, v244
    v_mul_f32 v228, s28, v228
    v_mul_f32 v229, s28, v229
    v_cvt_pk_bf16_f32 v244, v228, v229
    v_lshlrev_b32 v230, 16, v245
    v_and_b32 v231, s45, v245
    v_mfma_f32_16x16x32_bf16 v[116:119], a[164:167], v[56:59], v[116:119]
    s_waitcnt lgkmcnt(1)
    v_exp_f32 v34, v34
    v_mfma_f32_16x16x32_bf16 v[120:123], a[168:171], v[56:59], v[120:123]
    v_mul_f32 v230, s28, v230
    v_mul_f32 v231, s28, v231
    v_cvt_pk_bf16_f32 v245, v230, v231
    v_lshlrev_b32 v228, 16, v246
    v_and_b32 v229, s45, v246
    v_mul_f32 v228, s28, v228
    v_mfma_f32_16x16x32_bf16 v[152:155], a[168:171], v[60:63], v[152:155]
    v_exp_f32 v35, v35
    v_mfma_f32_16x16x32_bf16 v[156:159], a[172:175], v[60:63], v[156:159]
    v_cvt_pk_bf16_f32 v65, v34, v35
    v_mul_f32 v229, s28, v229
    v_mfma_f32_16x16x32_bf16 v[124:127], a[172:175], v[56:59], v[124:127]
    v_exp_f32 v36, v36
    v_mfma_f32_16x16x32_bf16 v[40:43], a[112:115], a[80:83], v[88:91]
    ds_read_b128 a[112:115], v4 offset:0
    v_add_u32 v5, s30, v3
    v_mfma_f32_16x16x32_bf16 v[40:43], a[116:119], a[84:87], v[40:43]
    v_exp_f32 v37, v37
    v_mfma_f32_16x16x32_bf16 v[40:43], a[120:123], a[88:91], v[40:43]
    ds_read_b128 a[116:119], v4 offset:256
    v_cvt_pk_bf16_f32 v66, v36, v37
    v_mfma_f32_16x16x32_bf16 v[40:43], a[124:127], a[92:95], v[40:43]
    v_exp_f32 v38, v38
    v_mfma_f32_16x16x32_bf16 v[44:47], a[128:131], a[80:83], v[88:91]
    ds_read_b128 a[120:123], v4 offset:512
    ds_read_b128 a[124:127], v4 offset:768
    v_mfma_f32_16x16x32_bf16 v[44:47], a[132:135], a[84:87], v[44:47]
    v_exp_f32 v39, v39
    v_mfma_f32_16x16x32_bf16 v[44:47], a[136:139], a[88:91], v[44:47]
    ds_read_b128 a[128:131], v4 offset:1024
    v_cvt_pk_bf16_f32 v67, v38, v39
    v_mfma_f32_16x16x32_bf16 v[44:47], a[140:143], a[92:95], v[44:47]
    ds_read_b128 a[132:135], v4 offset:1280
    ds_read_b128 a[136:139], v4 offset:1536
    v_mfma_f32_16x16x32_bf16 a[192:195], a[196:199], v[72:75], a[192:195]
    v_exp_f32 v40, v40
    v_mfma_f32_16x16x32_bf16 a[0:3], a[144:147], v[72:75], a[0:3]
    ds_read_b128 a[140:143], v4 offset:1792
    v_add_u32 v4, s30, v2
    v_mfma_f32_16x16x32_bf16 a[4:7], a[148:151], v[72:75], a[4:7]
    v_exp_f32 v41, v41
    v_mfma_f32_16x16x32_bf16 a[8:11], a[152:155], v[72:75], a[8:11]
    v_cvt_pk_bf16_f32 v68, v40, v41
    v_cvt_pk_bf16_f32 v246, v228, v229
    v_mfma_f32_16x16x32_bf16 a[12:15], a[156:159], v[72:75], a[12:15]
    v_exp_f32 v42, v42
    v_mfma_f32_16x16x32_bf16 a[16:19], a[160:163], v[72:75], a[16:19]
    v_lshlrev_b32 v230, 16, v247
    v_and_b32 v231, s45, v247
    v_mfma_f32_16x16x32_bf16 a[20:23], a[164:167], v[72:75], a[20:23]
    v_exp_f32 v43, v43
    v_mfma_f32_16x16x32_bf16 a[24:27], a[168:171], v[72:75], a[24:27]
    v_cvt_pk_bf16_f32 v69, v42, v43
    v_mul_f32 v230, s28, v230
    v_mfma_f32_16x16x32_bf16 a[28:31], a[172:175], v[72:75], a[28:31]
    s_waitcnt lgkmcnt(0)
    v_exp_f32 v44, v44
    v_mfma_f32_16x16x32_bf16 v[16:19], a[112:115], a[32:35], v[76:79]
    v_mul_f32 v231, s28, v231
    v_cvt_pk_bf16_f32 v247, v230, v231
    v_mfma_f32_16x16x32_bf16 v[16:19], a[116:119], a[36:39], v[16:19]
    v_exp_f32 v45, v45
    v_mfma_f32_16x16x32_bf16 v[16:19], a[120:123], a[40:43], v[16:19]
    ds_write_b128 v10, v[244:247] offset:1024
    v_cvt_pk_bf16_f32 v70, v44, v45
    v_mfma_f32_16x16x32_bf16 v[16:19], a[124:127], a[44:47], v[16:19]
    v_exp_f32 v46, v46
    v_mfma_f32_16x16x32_bf16 v[20:23], a[128:131], a[32:35], v[76:79]
    v_mfma_f32_16x16x32_bf16 v[20:23], a[132:135], a[36:39], v[20:23]
    v_exp_f32 v47, v47
    v_mfma_f32_16x16x32_bf16 v[20:23], a[136:139], a[40:43], v[20:23]
    s_sub_u32 s33, s33, 1
    v_cvt_pk_bf16_f32 v71, v46, v47
    v_mfma_f32_16x16x32_bf16 v[20:23], a[140:143], a[44:47], v[20:23]
    s_cbranch_scc1 L_Ax
    v_mfma_f32_16x16x32_bf16 v[24:27], a[112:115], a[48:51], v[80:83]
    v_exp_f32 v16, v16
    v_mfma_f32_16x16x32_bf16 v[24:27], a[116:119], a[52:55], v[24:27]
    s_waitcnt vmcnt(20) lgkmcnt(0)
    s_barrier
    v_mfma_f32_16x16x32_bf16 v[24:27], a[120:123], a[56:59], v[24:27]
    s_add_u32 s38, s38, 2176
    v_exp_f32 v17, v17
    v_mfma_f32_16x16x32_bf16 v[24:27], a[124:127], a[60:63], v[24:27]
    s_cmp_lt_u32 s38, 19584
    v_cvt_pk_bf16_f32 v56, v16, v17
    v_mfma_f32_16x16x32_bf16 v[28:31], a[128:131], a[48:51], v[80:83]
    s_cselect_b32 s42, s38, s39
    v_exp_f32 v18, v18
    v_mfma_f32_16x16x32_bf16 v[28:31], a[132:135], a[52:55], v[28:31]
    buffer_load_dwordx4 v1, s[16:19], s64 offen nt lds
    v_mfma_f32_16x16x32_bf16 v[28:31], a[136:139], a[56:59], v[28:31]
    v_exp_f32 v19, v19
    v_mfma_f32_16x16x32_bf16 v[28:31], a[140:143], a[60:63], v[28:31]
    v_cvt_pk_bf16_f32 v57, v18, v19
    v_add_u32 v10, s42, v11
    v_mfma_f32_16x16x32_bf16 a[184:187], a[196:199], v[64:67], a[184:187]
    v_exp_f32 v20, v20
    v_mfma_f32_16x16x32_bf16 a[188:191], a[196:199], v[68:71], a[188:191]
    buffer_load_dwordx4 v1, s[16:19], s64 offen offset:1024 nt lds
    v_mfma_f32_16x16x32_bf16 v[160:163], a[144:147], v[64:67], v[160:163]
    v_exp_f32 v21, v21
    v_mfma_f32_16x16x32_bf16 v[192:195], a[144:147], v[68:71], v[192:195]
    ds_read_b128 v[240:243], v10 offset:0
    v_cvt_pk_bf16_f32 v58, v20, v21
    v_mfma_f32_16x16x32_bf16 v[196:199], a[148:151], v[68:71], v[196:199]
    v_exp_f32 v22, v22
    v_mfma_f32_16x16x32_bf16 v[164:167], a[148:151], v[64:67], v[164:167]
    buffer_load_dwordx4 v1, s[20:23], s65 offen offset:2048 nt lds
    v_mfma_f32_16x16x32_bf16 v[168:171], a[152:155], v[64:67], v[168:171]
    v_exp_f32 v23, v23
    v_mfma_f32_16x16x32_bf16 v[200:203], a[152:155], v[68:71], v[200:203]
    ds_read_b128 v[244:247], v10 offset:1024
    v_cvt_pk_bf16_f32 v59, v22, v23
    v_mfma_f32_16x16x32_bf16 v[204:207], a[156:159], v[68:71], v[204:207]
    buffer_load_dwordx4 v1, s[20:23], s65 offen offset:3072 nt lds
    v_mfma_f32_16x16x32_bf16 v[172:175], a[156:159], v[64:67], v[172:175]
    s_mov_b32 s65, s64
    v_exp_f32 v24, v24
    v_mfma_f32_16x16x32_bf16 v[176:179], a[160:163], v[64:67], v[176:179]
    s_add_u32 s31, s31, 8192
    ds_read_b64_tr_b16 a[144:145], v5 offset:2048
    ds_read_b64_tr_b16 a[146:147], v5 offset:3072
    v_mfma_f32_16x16x32_bf16 v[208:211], a[160:163], v[68:71], v[208:211]
    s_or_b32 s31, s31, s67
    v_exp_f32 v25, v25
    v_mfma_f32_16x16x32_bf16 v[212:215], a[164:167], v[68:71], v[212:215]
    s_xor_b32 s64, s31, s66
    ds_read_b64_tr_b16 a[148:149], v5 offset:2080
    v_cvt_pk_bf16_f32 v60, v24, v25
    v_mfma_f32_16x16x32_bf16 v[180:183], a[164:167], v[64:67], v[180:183]
    s_cmp_ge_u32 s33, 6
    v_exp_f32 v26, v26
    v_mfma_f32_16x16x32_bf16 v[184:187], a[168:171], v[64:67], v[184:187]
    s_waitcnt lgkmcnt(3)
    s_cselect_b32 m0, s36, 160896
    ds_read_b64_tr_b16 a[150:151], v5 offset:3104
    ds_read_b64_tr_b16 a[152:153], v5 offset:2304
    v_lshlrev_b32 v228, 16, v240
    v_mfma_f32_16x16x32_bf16 v[216:219], a[168:171], v[68:71], v[216:219]
    s_cselect_b32 s41, s37, s35
    v_exp_f32 v27, v27
    v_and_b32 v229, s45, v240
    v_mfma_f32_16x16x32_bf16 v[220:223], a[172:175], v[68:71], v[220:223]
    ds_read_b64_tr_b16 a[154:155], v5 offset:3328
    v_cvt_pk_bf16_f32 v61, v26, v27
    v_mfma_f32_16x16x32_bf16 v[188:191], a[172:175], v[64:67], v[188:191]
    v_exp_f32 v28, v28
    v_mul_f32 v228, s28, v228
    v_mfma_f32_16x16x32_bf16 v[32:35], a[112:115], a[64:67], v[84:87]
    ds_read_b64_tr_b16 a[156:157], v5 offset:2336
    ds_read_b64_tr_b16 a[158:159], v5 offset:3360
    v_mul_f32 v229, s28, v229
    v_mfma_f32_16x16x32_bf16 v[32:35], a[116:119], a[68:71], v[32:35]
    v_exp_f32 v29, v29
    v_cvt_pk_bf16_f32 v240, v228, v229
    v_mfma_f32_16x16x32_bf16 v[32:35], a[120:123], a[72:75], v[32:35]
    ds_read_b64_tr_b16 a[160:161], v5 offset:2560
    v_cvt_pk_bf16_f32 v62, v28, v29
    v_mfma_f32_16x16x32_bf16 v[32:35], a[124:127], a[76:79], v[32:35]
    v_exp_f32 v30, v30
    v_mfma_f32_16x16x32_bf16 v[36:39], a[128:131], a[64:67], v[84:87]
    ds_read_b64_tr_b16 a[162:163], v5 offset:3584
    ds_read_b64_tr_b16 a[164:165], v5 offset:2592
    v_mfma_f32_16x16x32_bf16 v[36:39], a[132:135], a[68:71], v[36:39]
    v_exp_f32 v31, v31
    v_mfma_f32_16x16x32_bf16 v[36:39], a[136:139], a[72:75], v[36:39]
    ds_read_b64_tr_b16 a[166:167], v5 offset:3616
    v_cvt_pk_bf16_f32 v63, v30, v31
    v_mfma_f32_16x16x32_bf16 v[36:39], a[140:143], a[76:79], v[36:39]
    ds_read_b64_tr_b16 a[168:169], v5 offset:2816
    ds_read_b64_tr_b16 a[170:171], v5 offset:3840
    v_mfma_f32_16x16x32_bf16 v[40:43], a[112:115], a[80:83], v[88:91]
    v_exp_f32 v32, v32
    v_mfma_f32_16x16x32_bf16 v[40:43], a[116:119], a[84:87], v[40:43]
    ds_read_b64_tr_b16 a[172:173], v5 offset:2848
    ds_read_b64_tr_b16 a[174:175], v5 offset:3872
    v_mfma_f32_16x16x32_bf16 v[40:43], a[120:123], a[88:91], v[40:43]
    v_exp_f32 v33, v33
    v_mfma_f32_16x16x32_bf16 v[40:43], a[124:127], a[92:95], v[40:43]
    ds_read_b128 a[112:115], v4 offset:0
    v_cvt_pk_bf16_f32 v64, v32, v33
    v_mfma_f32_16x16x32_bf16 v[44:47], a[128:131], a[80:83], v[88:91]
    v_exp_f32 v34, v34
    v_mfma_f32_16x16x32_bf16 v[44:47], a[132:135], a[84:87], v[44:47]
    ds_read_b128 a[116:119], v4 offset:256
    ds_read_b128 a[120:123], v4 offset:512
    v_mfma_f32_16x16x32_bf16 v[44:47], a[136:139], a[88:91], v[44:47]
    v_exp_f32 v35, v35
    v_mfma_f32_16x16x32_bf16 v[44:47], a[140:143], a[92:95], v[44:47]
    ds_read_b128 a[124:127], v4 offset:768
    v_cvt_pk_bf16_f32 v65, v34, v35
    v_mfma_f32_16x16x32_bf16 a[176:179], a[196:199], v[56:59], a[176:179]
    v_exp_f32 v36, v36
    v_mfma_f32_16x16x32_bf16 a[180:183], a[196:199], v[60:63], a[180:183]
    s_waitcnt lgkmcnt(4)
    ds_read_b128 a[128:131], v4 offset:1024
    ds_read_b128 a[132:135], v4 offset:1280
    v_mfma_f32_16x16x32_bf16 v[96:99], a[144:147], v[56:59], v[96:99]
    v_exp_f32 v37, v37
    v_mfma_f32_16x16x32_bf16 v[128:131], a[144:147], v[60:63], v[128:131]
    ds_read_b128 a[136:139], v4 offset:1536
    v_cvt_pk_bf16_f32 v66, v36, v37
    v_mfma_f32_16x16x32_bf16 v[132:135], a[148:151], v[60:63], v[132:135]
    v_exp_f32 v38, v38
    v_mfma_f32_16x16x32_bf16 v[100:103], a[148:151], v[56:59], v[100:103]
    ds_read_b128 a[140:143], v4 offset:1792
    v_lshlrev_b32 v230, 16, v241
    v_mfma_f32_16x16x32_bf16 v[104:107], a[152:155], v[56:59], v[104:107]
    v_exp_f32 v39, v39
    v_mfma_f32_16x16x32_bf16 v[136:139], a[152:155], v[60:63], v[136:139]
    v_cvt_pk_bf16_f32 v67, v38, v39
    v_and_b32 v231, s45, v241
    v_mul_f32 v230, s28, v230
    v_mul_f32 v231, s28, v231
    v_cvt_pk_bf16_f32 v241, v230, v231
    v_lshlrev_b32 v228, 16, v242
    v_and_b32 v229, s45, v242
    v_mul_f32 v228, s28, v228
    v_mfma_f32_16x16x32_bf16 v[140:143], a[156:159], v[60:63], v[140:143]
    buffer_load_dwordx4 v1, s[12:15], s41 offen nt lds
    v_mfma_f32_16x16x32_bf16 v[108:111], a[156:159], v[56:59], v[108:111]
    v_exp_f32 v40, v40
    v_mfma_f32_16x16x32_bf16 v[112:115], a[160:163], v[56:59], v[112:115]
    buffer_load_dwordx4 v1, s[12:15], s41 offen offset:1024 nt lds
    v_mfma_f32_16x16x32_bf16 v[144:147], a[160:163], v[60:63], v[144:147]
    s_add_u32 s36, s36, 2176
    v_exp_f32 v41, v41
    v_mfma_f32_16x16x32_bf16 v[148:151], a[164:167], v[60:63], v[148:151]
    s_add_u32 s37, s37, 2048
    v_cvt_pk_bf16_f32 v68, v40, v41
    v_mul_f32 v229, s28, v229
    v_cvt_pk_bf16_f32 v242, v228, v229
    v_lshlrev_b32 v230, 16, v243
    v_and_b32 v231, s45, v243
    v_mul_f32 v230, s28, v230
    v_mul_f32 v231, s28, v231
    v_cvt_pk_bf16_f32 v243, v230, v231
    v_mfma_f32_16x16x32_bf16 v[116:119], a[164:167], v[56:59], v[116:119]
    s_add_u32 m0, s30, s32
    v_exp_f32 v42, v42
    v_mfma_f32_16x16x32_bf16 v[120:123], a[168:171], v[56:59], v[120:123]
    s_add_u32 s30, s30, 16512
    ds_write_b128 v10, v[240:243] offset:0
    v_lshlrev_b32 v228, 16, v244
    v_and_b32 v229, s45, v244
    v_mul_f32 v228, s28, v228
    v_mul_f32 v229, s28, v229
    v_cvt_pk_bf16_f32 v244, v228, v229
    v_lshlrev_b32 v230, 16, v245
    v_mfma_f32_16x16x32_bf16 v[152:155], a[168:171], v[60:63], v[152:155]
    s_cmp_eq_u32 s30, 82560
    v_exp_f32 v43, v43
    v_mfma_f32_16x16x32_bf16 v[156:159], a[172:175], v[60:63], v[156:159]
    s_cselect_b32 s30, 0, s30
    v_cvt_pk_bf16_f32 v69, v42, v43
    v_and_b32 v231, s45, v245
    v_mul_f32 v230, s28, v230
    v_mul_f32 v231, s28, v231
    v_cvt_pk_bf16_f32 v245, v230, v231
    v_lshlrev_b32 v228, 16, v246
    v_and_b32 v229, s45, v246
    v_mul_f32 v228, s28, v228
    v_mfma_f32_16x16x32_bf16 v[124:127], a[172:175], v[56:59], v[124:127]
    s_waitcnt lgkmcnt(1)
    v_exp_f32 v44, v44
    v_mfma_f32_16x16x32_bf16 v[16:19], a[112:115], a[32:35], v[76:79]
    v_add_u32 v5, s30, v3
    v_mul_f32 v229, s28, v229
    v_cvt_pk_bf16_f32 v246, v228, v229
    v_lshlrev_b32 v230, 16, v247
    v_and_b32 v231, s45, v247
    v_mul_f32 v230, s28, v230
    v_mul_f32 v231, s28, v231
    v_cvt_pk_bf16_f32 v247, v230, v231
    v_mfma_f32_16x16x32_bf16 v[16:19], a[116:119], a[36:39], v[16:19]
    v_exp_f32 v45, v45
    v_mfma_f32_16x16x32_bf16 v[16:19], a[120:123], a[40:43], v[16:19]
    ds_write_b128 v10, v[244:247] offset:1024
    v_cvt_pk_bf16_f32 v70, v44, v45
    v_mfma_f32_16x16x32_bf16 v[16:19], a[124:127], a[44:47], v[16:19]
    v_exp_f32 v46, v46
    v_mfma_f32_16x16x32_bf16 v[20:23], a[128:131], a[32:35], v[76:79]
    v_add_u32 v4, s30, v2
    v_mfma_f32_16x16x32_bf16 v[20:23], a[132:135], a[36:39], v[20:23]
    v_exp_f32 v47, v47
    v_mfma_f32_16x16x32_bf16 v[20:23], a[136:139], a[40:43], v[20:23]
    s_sub_u32 s33, s33, 1
    v_cvt_pk_bf16_f32 v71, v46, v47
    v_mfma_f32_16x16x32_bf16 v[20:23], a[140:143], a[44:47], v[20:23]
    s_cbranch_scc0 L_A0
    s_branch L_T1
    .p2align 12
L_pa3:
    s_branch L_wa
L_pb3:
    s_branch L_wb0
L_pg3:
L_T1:
    v_mfma_f32_16x16x32_bf16 v[24:27], a[112:115], a[48:51], v[80:83]
    v_exp_f32 v16, v16
    v_mfma_f32_16x16x32_bf16 v[24:27], a[116:119], a[52:55], v[24:27]
    ds_read_b128 a[32:35], v6 offset:0
    ds_read_b128 a[36:39], v6 offset:256
    v_mfma_f32_16x16x32_bf16 v[24:27], a[120:123], a[56:59], v[24:27]
    v_exp_f32 v17, v17
    v_mfma_f32_16x16x32_bf16 v[24:27], a[124:127], a[60:63], v[24:27]
    ds_read_b128 a[40:43], v6 offset:512
    v_cvt_pk_bf16_f32 v56, v16, v17
    v_mfma_f32_16x16x32_bf16 v[28:31], a[128:131], a[48:51], v[80:83]
    v_exp_f32 v18, v18
    v_mfma_f32_16x16x32_bf16 v[28:31], a[132:135], a[52:55], v[28:31]
    v_accvgpr_read_b32 v10, a226
    v_subrev_u32 v10, 6528, v10
    v_mfma_f32_16x16x32_bf16 v[28:31], a[136:139], a[56:59], v[28:31]
    s_mov_b32 s38, 4294961152
    v_exp_f32 v19, v19
    v_mfma_f32_16x16x32_bf16 v[28:31], a[140:143], a[60:63], v[28:31]
    s_mov_b32 s33, 3
    ds_read_b128 a[44:47], v6 offset:768
    v_cvt_pk_bf16_f32 v57, v18, v19
    v_mfma_f32_16x16x32_bf16 a[184:187], a[196:199], v[64:67], a[184:187]
    v_exp_f32 v20, v20
    v_mfma_f32_16x16x32_bf16 a[188:191], a[196:199], v[68:71], a[188:191]
    s_waitcnt vmcnt(20) lgkmcnt(0)
    s_barrier
    v_mfma_f32_16x16x32_bf16 v[160:163], a[144:147], v[64:67], v[160:163]
    v_exp_f32 v21, v21
    v_mfma_f32_16x16x32_bf16 v[192:195], a[144:147], v[68:71], v[192:195]
    ds_read_b64_tr_b16 a[144:145], v5 offset:2048
    v_cvt_pk_bf16_f32 v58, v20, v21
    v_mfma_f32_16x16x32_bf16 v[196:199], a[148:151], v[68:71], v[196:199]
    v_exp_f32 v22, v22
    v_mfma_f32_16x16x32_bf16 v[164:167], a[148:151], v[64:67], v[164:167]
    buffer_load_dwordx4 v1, s[16:19], s64 offen nt lds
    v_mfma_f32_16x16x32_bf16 v[168:171], a[152:155], v[64:67], v[168:171]
    v_exp_f32 v23, v23
    v_mfma_f32_16x16x32_bf16 v[200:203], a[152:155], v[68:71], v[200:203]
    ds_read_b64_tr_b16 a[146:147], v5 offset:3072
    v_cvt_pk_bf16_f32 v59, v22, v23
    v_mfma_f32_16x16x32_bf16 v[204:207], a[156:159], v[68:71], v[204:207]
    buffer_load_dwordx4 v1, s[16:19], s64 offen offset:1024 nt lds
    v_mfma_f32_16x16x32_bf16 v[172:175], a[156:159], v[64:67], v[172:175]
    v_exp_f32 v24, v24
    v_mfma_f32_16x16x32_bf16 v[176:179], a[160:163], v[64:67], v[176:179]
    buffer_load_dwordx4 v1, s[20:23], s65 offen offset:2048 nt lds
    v_mfma_f32_16x16x32_bf16 v[208:211], a[160:163], v[68:71], v[208:211]
    v_exp_f32 v25, v25
    v_mfma_f32_16x16x32_bf16 v[212:215], a[164:167], v[68:71], v[212:215]
    ds_read_b64_tr_b16 a[148:149], v5 offset:2080
    v_cvt_pk_bf16_f32 v60, v24, v25
    v_mfma_f32_16x16x32_bf16 v[180:183], a[164:167], v[64:67], v[180:183]
    v_exp_f32 v26, v26
    v_mfma_f32_16x16x32_bf16 v[184:187], a[168:171], v[64:67], v[184:187]
    buffer_load_dwordx4 v1, s[20:23], s65 offen offset:3072 nt lds
    v_mfma_f32_16x16x32_bf16 v[216:219], a[168:171], v[68:71], v[216:219]
    s_mov_b32 s65, s64
    v_exp_f32 v27, v27
    v_mfma_f32_16x16x32_bf16 v[220:223], a[172:175], v[68:71], v[220:223]
    s_add_u32 s31, s31, 8192
    ds_read_b64_tr_b16 a[150:151], v5 offset:3104
    v_cvt_pk_bf16_f32 v61, v26, v27
    v_mfma_f32_16x16x32_bf16 v[188:191], a[172:175], v[64:67], v[188:191]
    s_or_b32 s31, s31, s67
    v_exp_f32 v28, v28
    v_mfma_f32_16x16x32_bf16 v[48:51], a[112:115], a[96:99], v[92:95]
    s_xor_b32 s64, s31, s66
    ds_read_b64_tr_b16 a[152:153], v5 offset:2304
    ds_read_b64_tr_b16 a[154:155], v5 offset:3328
    v_mfma_f32_16x16x32_bf16 v[48:51], a[116:119], a[100:103], v[48:51]
    s_add_u32 m0, s30, s32
    v_exp_f32 v29, v29
    v_mfma_f32_16x16x32_bf16 v[48:51], a[120:123], a[104:107], v[48:51]
    s_add_u32 s30, s30, 16512
    ds_read_b64_tr_b16 a[156:157], v5 offset:2336
    v_cvt_pk_bf16_f32 v62, v28, v29
    v_mfma_f32_16x16x32_bf16 v[48:51], a[124:127], a[108:111], v[48:51]
    s_cmp_eq_u32 s30, 82560
    v_exp_f32 v30, v30
    v_mfma_f32_16x16x32_bf16 v[52:55], a[128:131], a[96:99], v[92:95]
    s_cselect_b32 s30, 0, s30
    ds_read_b64_tr_b16 a[158:159], v5 offset:3360
    ds_read_b64_tr_b16 a[160:161], v5 offset:2560
    v_mfma_f32_16x16x32_bf16 v[52:55], a[132:135], a[100:103], v[52:55]
    v_exp_f32 v31, v31
    v_mfma_f32_16x16x32_bf16 v[52:55], a[136:139], a[104:107], v[52:55]
    ds_read_b64_tr_b16 a[162:163], v5 offset:3584
    v_cvt_pk_bf16_f32 v63, v30, v31
    v_mfma_f32_16x16x32_bf16 v[52:55], a[140:143], a[108:111], v[52:55]
    ds_read_b64_tr_b16 a[164:165], v5 offset:2592
    ds_read_b64_tr_b16 a[166:167], v5 offset:3616
    v_mfma_f32_16x16x32_bf16 v[32:35], a[112:115], a[64:67], v[84:87]
    v_exp_f32 v48, v48
    v_mfma_f32_16x16x32_bf16 v[32:35], a[116:119], a[68:71], v[32:35]
    ds_read_b64_tr_b16 a[168:169], v5 offset:2816
    ds_read_b64_tr_b16 a[170:171], v5 offset:3840
    v_mfma_f32_16x16x32_bf16 v[32:35], a[120:123], a[72:75], v[32:35]
    v_exp_f32 v49, v49
    v_mfma_f32_16x16x32_bf16 v[32:35], a[124:127], a[76:79], v[32:35]
    ds_read_b64_tr_b16 a[172:173], v5 offset:2848
    v_cvt_pk_bf16_f32 v72, v48, v49
    v_mfma_f32_16x16x32_bf16 v[36:39], a[128:131], a[64:67], v[84:87]
    v_exp_f32 v50, v50
    v_mfma_f32_16x16x32_bf16 v[36:39], a[132:135], a[68:71], v[36:39]
    ds_read_b64_tr_b16 a[174:175], v5 offset:3872
    v_add_u32 v5, s30, v3
    v_mfma_f32_16x16x32_bf16 v[36:39], a[136:139], a[72:75], v[36:39]
    v_exp_f32 v51, v51
    v_mfma_f32_16x16x32_bf16 v[36:39], a[140:143], a[76:79], v[36:39]
    ds_read_b128 a[200:203], v15 offset:0
    v_cvt_pk_bf16_f32 v73, v50, v51
    v_mfma_f32_16x16x32_bf16 a[176:179], a[196:199], v[56:59], a[176:179]
    v_exp_f32 v52, v52
    v_mfma_f32_16x16x32_bf16 a[180:183], a[196:199], v[60:63], a[180:183]
    s_waitcnt lgkmcnt(3)
    ds_read_b128 a[204:207], v15 offset:256
    ds_read_b128 a[208:211], v15 offset:512
    v_mfma_f32_16x16x32_bf16 v[96:99], a[144:147], v[56:59], v[96:99]
    v_exp_f32 v53, v53
    v_mfma_f32_16x16x32_bf16 v[128:131], a[144:147], v[60:63], v[128:131]
    ds_read_b128 a[212:215], v15 offset:768
    v_cvt_pk_bf16_f32 v74, v52, v53
    v_mfma_f32_16x16x32_bf16 v[132:135], a[148:151], v[60:63], v[132:135]
    v_exp_f32 v54, v54
    v_mfma_f32_16x16x32_bf16 v[100:103], a[148:151], v[56:59], v[100:103]
    ds_read_b128 a[48:51], v6 offset:4352
    ds_read_b128 a[52:55], v6 offset:4608
    v_mfma_f32_16x16x32_bf16 v[104:107], a[152:155], v[56:59], v[104:107]
    v_exp_f32 v55, v55
    v_mfma_f32_16x16x32_bf16 v[136:139], a[152:155], v[60:63], v[136:139]
    ds_read_b128 a[56:59], v6 offset:4864
    v_cvt_pk_bf16_f32 v75, v54, v55
    v_mfma_f32_16x16x32_bf16 v[140:143], a[156:159], v[60:63], v[140:143]
    v_accvgpr_read_b32 v225, a176
    v_accvgpr_read_b32 v227, a180
    v_mfma_f32_16x16x32_bf16 v[108:111], a[156:159], v[56:59], v[108:111]
    v_exp_f32 v32, v32
    v_mfma_f32_16x16x32_bf16 v[112:115], a[160:163], v[56:59], v[112:115]
    v_rcp_f32 v224, v225
    v_add_f32 v14, v14, v225
    v_mfma_f32_16x16x32_bf16 v[144:147], a[160:163], v[60:63], v[144:147]
    v_exp_f32 v33, v33
    v_mfma_f32_16x16x32_bf16 v[148:151], a[164:167], v[60:63], v[148:151]
    ds_read_b128 a[60:63], v6 offset:5120
    v_cvt_pk_bf16_f32 v64, v32, v33
    v_mfma_f32_16x16x32_bf16 v[116:119], a[164:167], v[56:59], v[116:119]
    v_exp_f32 v34, v34
    v_mfma_f32_16x16x32_bf16 v[120:123], a[168:171], v[56:59], v[120:123]
    v_rcp_f32 v226, v227
    v_add_f32 v14, v14, v227
    v_mfma_f32_16x16x32_bf16 v[152:155], a[168:171], v[60:63], v[152:155]
    s_waitcnt lgkmcnt(1)
    v_exp_f32 v35, v35
    v_mfma_f32_16x16x32_bf16 v[156:159], a[172:175], v[60:63], v[156:159]
    ds_read_b128 a[96:99], v7 offset:0
    v_cvt_pk_bf16_f32 v65, v34, v35
    v_mfma_f32_16x16x32_bf16 v[124:127], a[172:175], v[56:59], v[124:127]
    v_exp_f32 v36, v36
    v_mfma_f32_16x16x32_bf16 v[76:79], a[200:203], a[32:35], 0
    v_pk_mul_f32 v[96:97], v[96:97], v[224:225] op_sel_hi:[1,0]
    v_pk_mul_f32 v[98:99], v[98:99], v[224:225] op_sel_hi:[1,0]
    v_pk_mul_f32 v[128:129], v[128:129], v[226:227] op_sel_hi:[1,0]
    v_pk_mul_f32 v[130:131], v[130:131], v[226:227] op_sel_hi:[1,0]
    v_pk_mul_f32 v[100:101], v[100:101], v[224:225] op_sel_hi:[1,0]
    v_pk_mul_f32 v[102:103], v[102:103], v[224:225] op_sel_hi:[1,0]
    v_pk_mul_f32 v[132:133], v[132:133], v[226:227] op_sel_hi:[1,0]
    v_pk_mul_f32 v[134:135], v[134:135], v[226:227] op_sel_hi:[1,0]
    v_pk_mul_f32 v[104:105], v[104:105], v[224:225] op_sel_hi:[1,0]
    v_pk_mul_f32 v[106:107], v[106:107], v[224:225] op_sel_hi:[1,0]
    v_pk_mul_f32 v[136:137], v[136:137], v[226:227] op_sel_hi:[1,0]
    v_pk_mul_f32 v[138:139], v[138:139], v[226:227] op_sel_hi:[1,0]
    v_pk_mul_f32 v[108:109], v[108:109], v[224:225] op_sel_hi:[1,0]
    v_pk_mul_f32 v[110:111], v[110:111], v[224:225] op_sel_hi:[1,0]
    v_pk_mul_f32 v[140:141], v[140:141], v[226:227] op_sel_hi:[1,0]
    v_pk_mul_f32 v[142:143], v[142:143], v[226:227] op_sel_hi:[1,0]
    v_pk_mul_f32 v[112:113], v[112:113], v[224:225] op_sel_hi:[1,0]
    v_pk_mul_f32 v[114:115], v[114:115], v[224:225] op_sel_hi:[1,0]
    v_pk_mul_f32 v[144:145], v[144:145], v[226:227] op_sel_hi:[1,0]
    v_pk_mul_f32 v[146:147], v[146:147], v[226:227] op_sel_hi:[1,0]
    v_pk_mul_f32 v[116:117], v[116:117], v[224:225] op_sel_hi:[1,0]
    v_pk_mul_f32 v[118:119], v[118:119], v[224:225] op_sel_hi:[1,0]
    v_pk_mul_f32 v[148:149], v[148:149], v[226:227] op_sel_hi:[1,0]
    v_pk_mul_f32 v[150:151], v[150:151], v[226:227] op_sel_hi:[1,0]
    v_pk_mul_f32 v[120:121], v[120:121], v[224:225] op_sel_hi:[1,0]
    v_pk_mul_f32 v[122:123], v[122:123], v[224:225] op_sel_hi:[1,0]
    v_pk_mul_f32 v[152:153], v[152:153], v[226:227] op_sel_hi:[1,0]
    v_pk_mul_f32 v[154:155], v[154:155], v[226:227] op_sel_hi:[1,0]
    v_pk_mul_f32 v[124:125], v[124:125], v[224:225] op_sel_hi:[1,0]
    v_pk_mul_f32 v[126:127], v[126:127], v[224:225] op_sel_hi:[1,0]
    v_pk_mul_f32 v[156:157], v[156:157], v[226:227] op_sel_hi:[1,0]
    v_pk_mul_f32 v[158:159], v[158:159], v[226:227] op_sel_hi:[1,0]
    v_cvt_pk_bf16_f32 v96, v96, v97
    v_cvt_pk_bf16_f32 v97, v98, v99
    v_mfma_f32_16x16x32_bf16 v[76:79], a[204:207], a[36:39], v[76:79]
    ds_write_b64 v8, v[96:97] offset:0
    v_mfma_f32_16x16x32_bf16 v[76:79], a[208:211], a[40:43], v[76:79]
    v_cvt_pk_bf16_f32 v128, v128, v129
    v_cvt_pk_bf16_f32 v129, v130, v131
    v_mfma_f32_16x16x32_bf16 v[76:79], a[212:215], a[44:47], v[76:79]
    ds_write_b64 v8, v[128:129] offset:4352
    v_cvt_pk_bf16_f32 v100, v100, v101
    v_mfma_f32_16x16x32_bf16 v[40:43], a[112:115], a[80:83], v[88:91]
    ds_read_b128 a[112:115], v4 offset:0
    ds_read_b128 a[100:103], v7 offset:256
    v_cvt_pk_bf16_f32 v101, v102, v103
    v_mfma_f32_16x16x32_bf16 v[40:43], a[116:119], a[84:87], v[40:43]
    ds_write_b64 v8, v[100:101] offset:32
    v_exp_f32 v37, v37
    v_cvt_pk_bf16_f32 v132, v132, v133
    v_mfma_f32_16x16x32_bf16 v[40:43], a[120:123], a[88:91], v[40:43]
    ds_read_b128 a[116:119], v4 offset:256
    v_cvt_pk_bf16_f32 v66, v36, v37
    v_mfma_f32_16x16x32_bf16 v[40:43], a[124:127], a[92:95], v[40:43]
    v_exp_f32 v38, v38
    v_cvt_pk_bf16_f32 v133, v134, v135
    v_mfma_f32_16x16x32_bf16 v[44:47], a[128:131], a[80:83], v[88:91]
    ds_read_b128 a[120:123], v4 offset:512
    ds_read_b128 a[124:127], v4 offset:768
    ds_write_b64 v8, v[132:133] offset:4384
    v_cvt_pk_bf16_f32 v104, v104, v105
    v_mfma_f32_16x16x32_bf16 v[44:47], a[132:135], a[84:87], v[44:47]
    v_exp_f32 v39, v39
    v_cvt_pk_bf16_f32 v105, v106, v107
    v_mfma_f32_16x16x32_bf16 v[44:47], a[136:139], a[88:91], v[44:47]
    ds_read_b128 a[128:131], v4 offset:1024
    v_cvt_pk_bf16_f32 v67, v38, v39
    v_mfma_f32_16x16x32_bf16 v[44:47], a[140:143], a[92:95], v[44:47]
    ds_read_b128 a[132:135], v4 offset:1280
    ds_read_b128 a[136:139], v4 offset:1536
    ds_write_b64 v8, v[104:105] offset:64
    v_cvt_pk_bf16_f32 v136, v136, v137
    v_mfma_f32_16x16x32_bf16 v[80:83], a[200:203], a[48:51], 0
    ds_read_b128 a[104:107], v7 offset:512
    v_sub_f32 v76, 0, v76
    v_mfma_f32_16x16x32_bf16 v[80:83], a[204:207], a[52:55], v[80:83]
    ds_read_b128 a[108:111], v7 offset:768
    v_sub_f32 v77, 0, v77
    v_mfma_f32_16x16x32_bf16 v[80:83], a[208:211], a[56:59], v[80:83]
    s_waitcnt lgkmcnt(9)
    ds_read_b128 a[64:67], v6 offset:8704
    v_sub_f32 v78, 0, v78
    v_mfma_f32_16x16x32_bf16 v[80:83], a[212:215], a[60:63], v[80:83]
    ds_read_b128 a[68:71], v6 offset:8960
    v_sub_f32 v79, 0, v79
    s_cbranch_vccnz L_fix1a0
L_fix1a0r:
    v_mfma_f32_16x16x32_bf16 a[192:195], a[196:199], v[72:75], a[192:195]
    v_exp_f32 v40, v40
    v_cvt_pk_bf16_f32 v137, v138, v139
    v_mfma_f32_16x16x32_bf16 a[0:3], a[144:147], v[72:75], a[0:3]
    ds_read_b128 a[140:143], v4 offset:1792
    v_add_u32 v4, s30, v2
    v_mfma_f32_16x16x32_bf16 a[4:7], a[148:151], v[72:75], a[4:7]
    ds_write_b64 v8, v[136:137] offset:4416
    v_exp_f32 v41, v41
    v_cvt_pk_bf16_f32 v108, v108, v109
    v_mfma_f32_16x16x32_bf16 a[8:11], a[152:155], v[72:75], a[8:11]
    ds_read_b128 a[72:75], v6 offset:9216
    v_cvt_pk_bf16_f32 v68, v40, v41
    v_mfma_f32_16x16x32_bf16 a[12:15], a[156:159], v[72:75], a[12:15]
    v_exp_f32 v42, v42
    v_cvt_pk_bf16_f32 v109, v110, v111
    v_mfma_f32_16x16x32_bf16 a[16:19], a[160:163], v[72:75], a[16:19]
    ds_read_b128 a[76:79], v6 offset:9472
    v_sub_f32 v80, 0, v80
    v_mfma_f32_16x16x32_bf16 a[20:23], a[164:167], v[72:75], a[20:23]
    ds_write_b64 v8, v[108:109] offset:96
    v_exp_f32 v43, v43
    v_cvt_pk_bf16_f32 v140, v140, v141
    v_mfma_f32_16x16x32_bf16 a[24:27], a[168:171], v[72:75], a[24:27]
    ds_read_b128 a[80:83], v6 offset:13056
    v_cvt_pk_bf16_f32 v69, v42, v43
    v_mfma_f32_16x16x32_bf16 a[28:31], a[172:175], v[72:75], a[28:31]
    v_exp_f32 v44, v44
    v_cvt_pk_bf16_f32 v141, v142, v143
    v_mfma_f32_16x16x32_bf16 v[92:95], a[200:203], a[96:99], 0
    ds_read_b128 a[84:87], v6 offset:13312
    v_sub_f32 v81, 0, v81
    v_mfma_f32_16x16x32_bf16 v[92:95], a[204:207], a[100:103], v[92:95]
    s_waitcnt lgkmcnt(4)
    ds_read_b128 a[88:91], v6 offset:13568
    v_sub_f32 v82, 0, v82
    v_mfma_f32_16x16x32_bf16 v[92:95], a[208:211], a[104:107], v[92:95]
    ds_read_b128 a[92:95], v6 offset:13824
    v_sub_f32 v83, 0, v83
    s_cbranch_vccnz L_fix1a1
L_fix1a1r:
    v_mfma_f32_16x16x32_bf16 v[92:95], a[212:215], a[108:111], v[92:95]
    ds_write_b64 v8, v[140:141] offset:4448
    v_mfma_f32_16x16x32_bf16 v[16:19], a[112:115], a[32:35], v[76:79]
    v_cvt_pk_bf16_f32 v112, v112, v113
    v_cvt_pk_bf16_f32 v113, v114, v115
    v_mfma_f32_16x16x32_bf16 v[16:19], a[116:119], a[36:39], v[16:19]
    v_exp_f32 v45, v45
    v_mfma_f32_16x16x32_bf16 v[16:19], a[120:123], a[40:43], v[16:19]
    ds_write_b64 v8, v[112:113] offset:128
    v_cvt_pk_bf16_f32 v70, v44, v45
    v_mfma_f32_16x16x32_bf16 v[16:19], a[124:127], a[44:47], v[16:19]
    v_exp_f32 v46, v46
    v_mfma_f32_16x16x32_bf16 v[20:23], a[128:131], a[32:35], v[76:79]
    v_sub_f32 v92, 0, v92
    v_cvt_pk_bf16_f32 v144, v144, v145
    v_cvt_pk_bf16_f32 v145, v146, v147
    v_mfma_f32_16x16x32_bf16 v[20:23], a[132:135], a[36:39], v[20:23]
    v_exp_f32 v47, v47
    v_mfma_f32_16x16x32_bf16 v[20:23], a[136:139], a[40:43], v[20:23]
    ds_write_b64 v8, v[144:145] offset:4480
    v_cvt_pk_bf16_f32 v71, v46, v47
    v_mfma_f32_16x16x32_bf16 v[20:23], a[140:143], a[44:47], v[20:23]
    v_sub_f32 v93, 0, v93
    v_cvt_pk_bf16_f32 v116, v116, v117
    v_cvt_pk_bf16_f32 v117, v118, v119
    v_mfma_f32_16x16x32_bf16 v[84:87], a[200:203], a[64:67], 0
    ds_write_b64 v8, v[116:117] offset:160
    v_sub_f32 v94, 0, v94
    v_mfma_f32_16x16x32_bf16 v[84:87], a[204:207], a[68:71], v[84:87]
    v_sub_f32 v95, 0, v95
    v_cvt_pk_bf16_f32 v148, v148, v149
    v_cvt_pk_bf16_f32 v149, v150, v151
    s_cbranch_vccnz L_fix1c
L_fix1cr:
    v_mfma_f32_16x16x32_bf16 v[84:87], a[208:211], a[72:75], v[84:87]
    s_waitcnt lgkmcnt(2)
    ds_write_b64 v8, v[148:149] offset:4512
    v_mfma_f32_16x16x32_bf16 v[84:87], a[212:215], a[76:79], v[84:87]
    v_cvt_pk_bf16_f32 v120, v120, v121
    v_cvt_pk_bf16_f32 v121, v122, v123
    v_mfma_f32_16x16x32_bf16 v[24:27], a[112:115], a[48:51], v[80:83]
    v_exp_f32 v16, v16
    v_mfma_f32_16x16x32_bf16 v[24:27], a[116:119], a[52:55], v[24:27]
    s_waitcnt vmcnt(18) lgkmcnt(0)
    s_barrier
    v_mfma_f32_16x16x32_bf16 v[24:27], a[120:123], a[56:59], v[24:27]
    v_exp_f32 v17, v17
    v_mfma_f32_16x16x32_bf16 v[24:27], a[124:127], a[60:63], v[24:27]
    ds_write_b128 v12, a[0:3] offset:0
    ds_write_b128 v12, a[4:7] offset:1024
    v_cvt_pk_bf16_f32 v56, v16, v17
    v_mfma_f32_16x16x32_bf16 v[28:31], a[128:131], a[48:51], v[80:83]
    v_exp_f32 v18, v18
    v_mfma_f32_16x16x32_bf16 v[28:31], a[132:135], a[52:55], v[28:31]
    ds_write_b128 v12, a[8:11] offset:2048
    v_mfma_f32_16x16x32_bf16 v[28:31], a[136:139], a[56:59], v[28:31]
    v_exp_f32 v19, v19
    v_mfma_f32_16x16x32_bf16 v[28:31], a[140:143], a[60:63], v[28:31]
    ds_write_b128 v12, a[12:15] offset:3072
    v_cvt_pk_bf16_f32 v57, v18, v19
    v_mfma_f32_16x16x32_bf16 v[88:91], a[200:203], a[80:83], 0
    ds_write_b64 v8, v[120:121] offset:192
    v_sub_f32 v84, 0, v84
    v_mfma_f32_16x16x32_bf16 v[88:91], a[204:207], a[84:87], v[88:91]
    v_sub_f32 v85, 0, v85
    v_cvt_pk_bf16_f32 v152, v152, v153
    v_cvt_pk_bf16_f32 v153, v154, v155
    v_mfma_f32_16x16x32_bf16 v[88:91], a[208:211], a[88:91], v[88:91]
    ds_write_b64 v8, v[152:153] offset:4544
    v_sub_f32 v86, 0, v86
    v_mfma_f32_16x16x32_bf16 v[88:91], a[212:215], a[92:95], v[88:91]
    v_sub_f32 v87, 0, v87
    v_cvt_pk_bf16_f32 v124, v124, v125
    v_cvt_pk_bf16_f32 v125, v126, v127
    s_cbranch_vccnz L_fix1b0
L_fix1b0r:
    v_mfma_f32_16x16x32_bf16 a[184:187], a[196:199], v[64:67], a[184:187]
    v_exp_f32 v20, v20
    v_mfma_f32_16x16x32_bf16 a[188:191], a[196:199], v[68:71], a[188:191]
    ds_write_b32 v13, a192 offset:0
    v_mfma_f32_16x16x32_bf16 v[160:163], a[144:147], v[64:67], v[160:163]
    v_exp_f32 v21, v21
    v_mfma_f32_16x16x32_bf16 v[192:195], a[144:147], v[68:71], v[192:195]
    ds_read_b64_tr_b16 a[144:145], v5 offset:2048
    v_cvt_pk_bf16_f32 v58, v20, v21
    v_mfma_f32_16x16x32_bf16 v[196:199], a[148:151], v[68:71], v[196:199]
    v_exp_f32 v22, v22
    v_sub_f32 v88, 0, v88
    v_mfma_f32_16x16x32_bf16 v[164:167], a[148:151], v[64:67], v[164:167]
    s_waitcnt lgkmcnt(0)
    s_barrier
    v_sub_f32 v89, 0, v89
    v_mfma_f32_16x16x32_bf16 v[168:171], a[152:155], v[64:67], v[168:171]
    v_exp_f32 v23, v23
    v_sub_f32 v90, 0, v90
    v_mfma_f32_16x16x32_bf16 v[200:203], a[152:155], v[68:71], v[200:203]
    ds_read_b128 v[240:243], v12 offset:4128
    v_cvt_pk_bf16_f32 v59, v22, v23
    v_mfma_f32_16x16x32_bf16 v[204:207], a[156:159], v[68:71], v[204:207]
    ds_read_b128 v[244:247], v12 offset:5152
    ds_read_b128 v[248:251], v12 offset:6176
    v_sub_f32 v91, 0, v91
    s_cbranch_vccnz L_fix1b1
L_fix1b1r:
    v_mfma_f32_16x16x32_bf16 v[172:175], a[156:159], v[64:67], v[172:175]
    v_exp_f32 v24, v24
    v_accvgpr_read_b32 v225, a184
    v_mfma_f32_16x16x32_bf16 v[176:179], a[160:163], v[64:67], v[176:179]
    ds_read_b128 v[252:255], v12 offset:7200
    ds_read_b32 v232, v13 offset:64
    v_accvgpr_read_b32 v227, a188
    v_rcp_f32 v224, v225
    v_mfma_f32_16x16x32_bf16 v[208:211], a[160:163], v[68:71], v[208:211]
    v_exp_f32 v25, v25
    v_add_f32 v14, v14, v225
    v_rcp_f32 v226, v227
    v_mfma_f32_16x16x32_bf16 v[212:215], a[164:167], v[68:71], v[212:215]
    ds_read_b64_tr_b16 a[146:147], v5 offset:3072
    v_cvt_pk_bf16_f32 v60, v24, v25
    v_mfma_f32_16x16x32_bf16 v[180:183], a[164:167], v[64:67], v[180:183]
    v_exp_f32 v26, v26
    v_add_f32 v14, v14, v227
    v_mfma_f32_16x16x32_bf16 v[184:187], a[168:171], v[64:67], v[184:187]
    ds_read_b64_tr_b16 a[148:149], v5 offset:2080
    ds_read_b64_tr_b16 a[150:151], v5 offset:3104
    v_mfma_f32_16x16x32_bf16 v[216:219], a[168:171], v[68:71], v[216:219]
    v_exp_f32 v27, v27
    v_mfma_f32_16x16x32_bf16 v[220:223], a[172:175], v[68:71], v[220:223]
    ds_read_b64_tr_b16 a[152:153], v5 offset:2304
    v_cvt_pk_bf16_f32 v61, v26, v27
    v_mfma_f32_16x16x32_bf16 v[188:191], a[172:175], v[64:67], v[188:191]
    s_waitcnt lgkmcnt(4)
    v_exp_f32 v28, v28
    v_mfma_f32_16x16x32_bf16 v[32:35], a[112:115], a[64:67], v[84:87]
    buffer_load_dwordx4 v1, s[16:19], s64 offen nt lds
    ds_write_b64 v8, v[124:125] offset:224
    v_pk_mul_f32 v[160:161], v[160:161], v[224:225] op_sel_hi:[1,0]
    v_pk_mul_f32 v[162:163], v[162:163], v[224:225] op_sel_hi:[1,0]
    v_pk_mul_f32 v[192:193], v[192:193], v[226:227] op_sel_hi:[1,0]
    v_pk_mul_f32 v[194:195], v[194:195], v[226:227] op_sel_hi:[1,0]
    v_pk_mul_f32 v[164:165], v[164:165], v[224:225] op_sel_hi:[1,0]
    v_pk_mul_f32 v[166:167], v[166:167], v[224:225] op_sel_hi:[1,0]
    v_pk_mul_f32 v[196:197], v[196:197], v[226:227] op_sel_hi:[1,0]
    v_pk_mul_f32 v[198:199], v[198:199], v[226:227] op_sel_hi:[1,0]
    v_pk_mul_f32 v[168:169], v[168:169], v[224:225] op_sel_hi:[1,0]
    v_pk_mul_f32 v[170:171], v[170:171], v[224:225] op_sel_hi:[1,0]
    v_pk_mul_f32 v[200:201], v[200:201], v[226:227] op_sel_hi:[1,0]
    v_pk_mul_f32 v[202:203], v[202:203], v[226:227] op_sel_hi:[1,0]
    v_pk_mul_f32 v[172:173], v[172:173], v[224:225] op_sel_hi:[1,0]
    v_pk_mul_f32 v[174:175], v[174:175], v[224:225] op_sel_hi:[1,0]
    v_pk_mul_f32 v[204:205], v[204:205], v[226:227] op_sel_hi:[1,0]
    v_pk_mul_f32 v[206:207], v[206:207], v[226:227] op_sel_hi:[1,0]
    v_pk_mul_f32 v[176:177], v[176:177], v[224:225] op_sel_hi:[1,0]
    v_pk_mul_f32 v[178:179], v[178:179], v[224:225] op_sel_hi:[1,0]
    v_pk_mul_f32 v[208:209], v[208:209], v[226:227] op_sel_hi:[1,0]
    v_pk_mul_f32 v[210:211], v[210:211], v[226:227] op_sel_hi:[1,0]
    v_pk_mul_f32 v[180:181], v[180:181], v[224:225] op_sel_hi:[1,0]
    v_pk_mul_f32 v[182:183], v[182:183], v[224:225] op_sel_hi:[1,0]
    v_pk_mul_f32 v[212:213], v[212:213], v[226:227] op_sel_hi:[1,0]
    v_pk_mul_f32 v[214:215], v[214:215], v[226:227] op_sel_hi:[1,0]
    v_pk_mul_f32 v[184:185], v[184:185], v[224:225] op_sel_hi:[1,0]
    v_pk_mul_f32 v[186:187], v[186:187], v[224:225] op_sel_hi:[1,0]
    v_pk_mul_f32 v[216:217], v[216:217], v[226:227] op_sel_hi:[1,0]
    v_pk_mul_f32 v[218:219], v[218:219], v[226:227] op_sel_hi:[1,0]
    v_pk_mul_f32 v[188:189], v[188:189], v[224:225] op_sel_hi:[1,0]
    v_pk_mul_f32 v[190:191], v[190:191], v[224:225] op_sel_hi:[1,0]
    v_pk_mul_f32 v[220:221], v[220:221], v[226:227] op_sel_hi:[1,0]
    v_pk_mul_f32 v[222:223], v[222:223], v[226:227] op_sel_hi:[1,0]
    v_cvt_pk_bf16_f32 v156, v156, v157
    v_cvt_pk_bf16_f32 v157, v158, v159
    v_cvt_pk_bf16_f32 v160, v160, v161
    v_cvt_pk_bf16_f32 v161, v162, v163
    v_accvgpr_read_b32 v233, a192
    v_add_f32 v232, v232, v233
    v_mfma_f32_16x16x32_bf16 v[32:35], a[116:119], a[68:71], v[32:35]
    ds_write_b64 v8, v[156:157] offset:4576
    ds_write_b64 v8, v[160:161] offset:8704
    v_exp_f32 v29, v29
    v_cvt_pk_bf16_f32 v192, v192, v193
    v_rcp_f32 v234, v232
    v_mfma_f32_16x16x32_bf16 v[32:35], a[120:123], a[72:75], v[32:35]
    ds_read_b64_tr_b16 a[154:155], v5 offset:3328
    v_cvt_pk_bf16_f32 v62, v28, v29
    v_mfma_f32_16x16x32_bf16 v[32:35], a[124:127], a[76:79], v[32:35]
    v_exp_f32 v30, v30
    v_cvt_pk_bf16_f32 v193, v194, v195
    v_mfma_f32_16x16x32_bf16 v[36:39], a[128:131], a[64:67], v[84:87]
    buffer_load_dwordx4 v1, s[16:19], s64 offen offset:1024 nt lds
    ds_write_b64 v8, v[192:193] offset:13056
    v_cvt_pk_bf16_f32 v164, v164, v165
    v_mfma_f32_16x16x32_bf16 v[36:39], a[132:135], a[68:71], v[36:39]
    v_exp_f32 v31, v31
    v_cvt_pk_bf16_f32 v165, v166, v167
    v_mfma_f32_16x16x32_bf16 v[36:39], a[136:139], a[72:75], v[36:39]
    ds_read_b64_tr_b16 a[156:157], v5 offset:2336
    v_cvt_pk_bf16_f32 v63, v30, v31
    v_mfma_f32_16x16x32_bf16 v[36:39], a[140:143], a[76:79], v[36:39]
    buffer_load_dwordx4 v1, s[20:23], s65 offen offset:2048 nt lds
    ds_write_b64 v8, v[164:165] offset:8736
    v_cvt_pk_bf16_f32 v196, v196, v197
    v_mfma_f32_16x16x32_bf16 v[40:43], a[112:115], a[80:83], v[88:91]
    v_exp_f32 v32, v32
    v_cvt_pk_bf16_f32 v197, v198, v199
    v_mfma_f32_16x16x32_bf16 v[40:43], a[116:119], a[84:87], v[40:43]
    buffer_load_dwordx4 v1, s[20:23], s65 offen offset:3072 nt lds
    ds_write_b64 v8, v[196:197] offset:13088
    v_cvt_pk_bf16_f32 v168, v168, v169
    v_mfma_f32_16x16x32_bf16 v[40:43], a[120:123], a[88:91], v[40:43]
    s_mov_b32 s65, s64
    v_exp_f32 v33, v33
    v_cvt_pk_bf16_f32 v169, v170, v171
    v_mfma_f32_16x16x32_bf16 v[40:43], a[124:127], a[92:95], v[40:43]
    s_add_u32 s31, s31, 8192
    ds_read_b64_tr_b16 a[158:159], v5 offset:3360
    v_cvt_pk_bf16_f32 v64, v32, v33
    v_mfma_f32_16x16x32_bf16 v[44:47], a[128:131], a[80:83], v[88:91]
    s_or_b32 s31, s31, s67
    ds_write_b64 v8, v[168:169] offset:8768
    v_exp_f32 v34, v34
    v_cvt_pk_bf16_f32 v200, v200, v201
    v_mfma_f32_16x16x32_bf16 v[44:47], a[132:135], a[84:87], v[44:47]
    s_xor_b32 s64, s31, s66
    ds_read_b64_tr_b16 a[160:161], v5 offset:2560
    ds_read_b64_tr_b16 a[162:163], v5 offset:3584
    v_cvt_pk_bf16_f32 v201, v202, v203
    v_mfma_f32_16x16x32_bf16 v[44:47], a[136:139], a[88:91], v[44:47]
    s_add_u32 m0, s30, s32
    ds_write_b64 v8, v[200:201] offset:13120
    v_exp_f32 v35, v35
    v_cvt_pk_bf16_f32 v172, v172, v173
    v_mfma_f32_16x16x32_bf16 v[44:47], a[140:143], a[92:95], v[44:47]
    s_add_u32 s30, s30, 16512
    ds_read_b64_tr_b16 a[164:165], v5 offset:2592
    v_cvt_pk_bf16_f32 v65, v34, v35
    v_mfma_f32_16x16x32_bf16 a[176:179], a[196:199], v[56:59], 0
    s_cmp_eq_u32 s30, 82560
    v_exp_f32 v36, v36
    v_cvt_pk_bf16_f32 v173, v174, v175
    v_mfma_f32_16x16x32_bf16 a[180:183], a[196:199], v[60:63], 0
    s_waitcnt lgkmcnt(6)
    s_cselect_b32 s30, 0, s30
    ds_read_b64_tr_b16 a[166:167], v5 offset:3616
    ds_read_b64_tr_b16 a[168:169], v5 offset:2816
    ds_write_b64 v8, v[172:173] offset:8800
    v_cvt_pk_bf16_f32 v204, v204, v205
    v_mfma_f32_16x16x32_bf16 v[96:99], a[144:147], v[56:59], 0
    v_exp_f32 v37, v37
    v_cvt_pk_bf16_f32 v205, v206, v207
    v_mfma_f32_16x16x32_bf16 v[128:131], a[144:147], v[60:63], 0
    ds_read_b64_tr_b16 a[170:171], v5 offset:3840
    v_cvt_pk_bf16_f32 v66, v36, v37
    v_mfma_f32_16x16x32_bf16 v[132:135], a[148:151], v[60:63], 0
    ds_write_b64 v8, v[204:205] offset:13152
    v_exp_f32 v38, v38
    v_cvt_pk_bf16_f32 v176, v176, v177
    v_mfma_f32_16x16x32_bf16 v[100:103], a[148:151], v[56:59], 0
    ds_read_b64_tr_b16 a[172:173], v5 offset:2848
    ds_read_b64_tr_b16 a[174:175], v5 offset:3872
    v_cvt_pk_bf16_f32 v177, v178, v179
    v_mfma_f32_16x16x32_bf16 v[104:107], a[152:155], v[56:59], 0
    ds_write_b64 v8, v[176:177] offset:8832
    v_exp_f32 v39, v39
    v_cvt_pk_bf16_f32 v208, v208, v209
    v_mfma_f32_16x16x32_bf16 v[136:139], a[152:155], v[60:63], 0
    s_waitcnt lgkmcnt(8)
    ds_read_b128 a[112:115], v4 offset:0
    v_cvt_pk_bf16_f32 v67, v38, v39
    v_mfma_f32_16x16x32_bf16 v[140:143], a[156:159], v[60:63], 0
    ds_read_b128 a[116:119], v4 offset:256
    ds_read_b128 a[120:123], v4 offset:512
    v_cvt_pk_bf16_f32 v209, v210, v211
    v_mfma_f32_16x16x32_bf16 v[108:111], a[156:159], v[56:59], 0
    v_exp_f32 v40, v40
    v_mfma_f32_16x16x32_bf16 v[112:115], a[160:163], v[56:59], 0
    ds_read_b128 a[124:127], v4 offset:768
    ds_read_b128 a[128:131], v4 offset:1024
    v_mfma_f32_16x16x32_bf16 v[144:147], a[160:163], v[60:63], 0
    s_waitcnt lgkmcnt(8)
    v_exp_f32 v41, v41
    v_mfma_f32_16x16x32_bf16 v[148:151], a[164:167], v[60:63], 0
    ds_read_b128 a[132:135], v4 offset:1280
    v_cvt_pk_bf16_f32 v68, v40, v41
    v_mfma_f32_16x16x32_bf16 v[116:119], a[164:167], v[56:59], 0
    v_exp_f32 v42, v42
    v_mfma_f32_16x16x32_bf16 v[120:123], a[168:171], v[56:59], 0
    ds_read_b128 a[136:139], v4 offset:1536
    ds_read_b128 a[140:143], v4 offset:1792
    v_mfma_f32_16x16x32_bf16 v[152:155], a[168:171], v[60:63], 0
    s_waitcnt lgkmcnt(5)
    v_exp_f32 v43, v43
    v_mfma_f32_16x16x32_bf16 v[156:159], a[172:175], v[60:63], 0
    ds_write_b64 v8, v[208:209] offset:13184
    v_cvt_pk_bf16_f32 v69, v42, v43
    s_branch L_pg4
    .p2align 12
L_pa4:
    s_branch L_wa
L_pb4:
    s_branch L_wb1
L_pg4:
    v_cvt_pk_bf16_f32 v180, v180, v181
    v_cvt_pk_bf16_f32 v181, v182, v183
    v_add_f32 v14, v14, v232
    v_accvgpr_read_b32 v228, a16
    v_accvgpr_read_b32 v229, a17
    v_accvgpr_read_b32 v230, a18
    v_accvgpr_read_b32 v231, a19
    v_add_f32 v240, v240, v228
    v_add_f32 v241, v241, v229
    v_mfma_f32_16x16x32_bf16 v[124:127], a[172:175], v[56:59], 0
    v_exp_f32 v44, v44
    v_mfma_f32_16x16x32_bf16 v[16:19], a[112:115], a[32:35], v[76:79]
    ds_write_b64 v8, v[180:181] offset:8864
    v_add_u32 v5, s30, v3
    v_mfma_f32_16x16x32_bf16 v[16:19], a[116:119], a[36:39], v[16:19]
    v_exp_f32 v45, v45
    v_mfma_f32_16x16x32_bf16 v[16:19], a[120:123], a[40:43], v[16:19]
    s_waitcnt lgkmcnt(4)
    v_cvt_pk_bf16_f32 v70, v44, v45
    v_cvt_pk_bf16_f32 v212, v212, v213
    v_cvt_pk_bf16_f32 v213, v214, v215
    v_add_f32 v242, v242, v230
    v_add_f32 v243, v243, v231
    v_mul_f32 v240, v240, v234
    v_mul_f32 v241, v241, v234
    v_mul_f32 v242, v242, v234
    v_mul_f32 v243, v243, v234
    v_cvt_pk_bf16_f32 v240, v240, v241
    v_mfma_f32_16x16x32_bf16 v[16:19], a[124:127], a[44:47], v[16:19]
    v_exp_f32 v46, v46
    v_mfma_f32_16x16x32_bf16 v[20:23], a[128:131], a[32:35], v[76:79]
    ds_write_b64 v8, v[212:213] offset:13216
    v_add_u32 v4, s30, v2
    v_mfma_f32_16x16x32_bf16 v[20:23], a[132:135], a[36:39], v[20:23]
    s_waitcnt lgkmcnt(2)
    v_exp_f32 v47, v47
    v_mfma_f32_16x16x32_bf16 v[20:23], a[136:139], a[40:43], v[20:23]
    v_cvt_pk_bf16_f32 v71, v46, v47
    v_cvt_pk_bf16_f32 v184, v184, v185
    v_cvt_pk_bf16_f32 v185, v186, v187
    v_cvt_pk_bf16_f32 v241, v242, v243
    v_mfma_f32_16x16x32_bf16 v[20:23], a[140:143], a[44:47], v[20:23]
    ds_write_b64 v8, v[184:185] offset:8896
    v_cvt_pk_bf16_f32 v216, v216, v217
    v_mfma_f32_16x16x32_bf16 v[24:27], a[112:115], a[48:51], v[80:83]
    v_exp_f32 v16, v16
    v_cvt_pk_bf16_f32 v217, v218, v219
    v_mfma_f32_16x16x32_bf16 v[24:27], a[116:119], a[52:55], v[24:27]
    ds_write_b64 v8, v[216:217] offset:13248
    v_mfma_f32_16x16x32_bf16 v[24:27], a[120:123], a[56:59], v[24:27]
    v_exp_f32 v17, v17
    v_mfma_f32_16x16x32_bf16 v[24:27], a[124:127], a[60:63], v[24:27]
    v_cvt_pk_bf16_f32 v56, v16, v17
    v_cvt_pk_bf16_f32 v188, v188, v189
    v_cvt_pk_bf16_f32 v189, v190, v191
    v_mfma_f32_16x16x32_bf16 v[28:31], a[128:131], a[48:51], v[80:83]
    v_exp_f32 v18, v18
    v_mfma_f32_16x16x32_bf16 v[28:31], a[132:135], a[52:55], v[28:31]
    ds_write_b64 v8, v[188:189] offset:8928
    v_cvt_pk_bf16_f32 v220, v220, v221
    v_mfma_f32_16x16x32_bf16 v[28:31], a[136:139], a[56:59], v[28:31]
    v_exp_f32 v19, v19
    v_cvt_pk_bf16_f32 v221, v222, v223
    v_mfma_f32_16x16x32_bf16 v[28:31], a[140:143], a[60:63], v[28:31]
    ds_write_b64 v8, v[220:221] offset:13280
    v_cvt_pk_bf16_f32 v57, v18, v19
    v_mfma_f32_16x16x32_bf16 a[184:187], a[196:199], v[64:67], 0
    v_exp_f32 v20, v20
    v_mfma_f32_16x16x32_bf16 a[188:191], a[196:199], v[68:71], 0
    s_waitcnt vmcnt(16) lgkmcnt(0)
    s_barrier
    v_mfma_f32_16x16x32_bf16 v[160:163], a[144:147], v[64:67], 0
    v_exp_f32 v21, v21
    v_mfma_f32_16x16x32_bf16 v[192:195], a[144:147], v[68:71], 0
    ds_read_b64_tr_b16 a[144:145], v5 offset:2048
    v_cvt_pk_bf16_f32 v58, v20, v21
    v_mfma_f32_16x16x32_bf16 v[196:199], a[148:151], v[68:71], 0
    v_exp_f32 v22, v22
    v_mfma_f32_16x16x32_bf16 v[164:167], a[148:151], v[64:67], 0
    buffer_load_dwordx4 v1, s[16:19], s64 offen nt lds
    v_mfma_f32_16x16x32_bf16 v[168:171], a[152:155], v[64:67], 0
    v_exp_f32 v23, v23
    v_mfma_f32_16x16x32_bf16 v[200:203], a[152:155], v[68:71], 0
    ds_read_b64_tr_b16 a[146:147], v5 offset:3072
    v_cvt_pk_bf16_f32 v59, v22, v23
    v_mfma_f32_16x16x32_bf16 v[204:207], a[156:159], v[68:71], 0
    buffer_load_dwordx4 v1, s[16:19], s64 offen offset:1024 nt lds
    v_mfma_f32_16x16x32_bf16 v[172:175], a[156:159], v[64:67], 0
    v_exp_f32 v24, v24
    v_mfma_f32_16x16x32_bf16 v[176:179], a[160:163], v[64:67], 0
    buffer_load_dwordx4 v1, s[20:23], s65 offen offset:2048 nt lds
    v_mfma_f32_16x16x32_bf16 v[208:211], a[160:163], v[68:71], 0
    v_exp_f32 v25, v25
    v_mfma_f32_16x16x32_bf16 v[212:215], a[164:167], v[68:71], 0
    ds_read_b64_tr_b16 a[148:149], v5 offset:2080
    v_cvt_pk_bf16_f32 v60, v24, v25
    v_mfma_f32_16x16x32_bf16 v[180:183], a[164:167], v[64:67], 0
    v_exp_f32 v26, v26
    v_mfma_f32_16x16x32_bf16 v[184:187], a[168:171], v[64:67], 0
    buffer_load_dwordx4 v1, s[20:23], s65 offen offset:3072 nt lds
    v_mfma_f32_16x16x32_bf16 v[216:219], a[168:171], v[68:71], 0
    s_mov_b32 s65, s64
    v_exp_f32 v27, v27
    v_mfma_f32_16x16x32_bf16 v[220:223], a[172:175], v[68:71], 0
    s_add_u32 s31, s31, 8192
    ds_read_b64_tr_b16 a[150:151], v5 offset:3104
    v_cvt_pk_bf16_f32 v61, v26, v27
    v_mfma_f32_16x16x32_bf16 v[188:191], a[172:175], v[64:67], 0
    s_or_b32 s31, s31, s67
    v_exp_f32 v28, v28
    v_mfma_f32_16x16x32_bf16 v[48:51], a[112:115], a[96:99], v[92:95]
    s_xor_b32 s64, s31, s66
    ds_read_b64_tr_b16 a[152:153], v5 offset:2304
    ds_read_b64_tr_b16 a[154:155], v5 offset:3328
    v_mfma_f32_16x16x32_bf16 v[48:51], a[116:119], a[100:103], v[48:51]
    s_add_u32 m0, s30, s32
    v_exp_f32 v29, v29
    v_mfma_f32_16x16x32_bf16 v[48:51], a[120:123], a[104:107], v[48:51]
    s_add_u32 s30, s30, 16512
    ds_read_b64_tr_b16 a[156:157], v5 offset:2336
    v_cvt_pk_bf16_f32 v62, v28, v29
    v_mfma_f32_16x16x32_bf16 v[48:51], a[124:127], a[108:111], v[48:51]
    s_cmp_eq_u32 s30, 82560
    v_exp_f32 v30, v30
    v_mfma_f32_16x16x32_bf16 v[52:55], a[128:131], a[96:99], v[92:95]
    s_cselect_b32 s30, 0, s30
    ds_read_b64_tr_b16 a[158:159], v5 offset:3360
    ds_read_b64_tr_b16 a[160:161], v5 offset:2560
    v_mfma_f32_16x16x32_bf16 v[52:55], a[132:135], a[100:103], v[52:55]
    v_exp_f32 v31, v31
    v_mfma_f32_16x16x32_bf16 v[52:55], a[136:139], a[104:107], v[52:55]
    ds_read_b64_tr_b16 a[162:163], v5 offset:3584
    v_cvt_pk_bf16_f32 v63, v30, v31
    v_mfma_f32_16x16x32_bf16 v[52:55], a[140:143], a[108:111], v[52:55]
    ds_read_b64_tr_b16 a[164:165], v5 offset:2592
    ds_read_b64_tr_b16 a[166:167], v5 offset:3616
    v_mfma_f32_16x16x32_bf16 v[32:35], a[112:115], a[64:67], v[84:87]
    v_exp_f32 v48, v48
    v_mfma_f32_16x16x32_bf16 v[32:35], a[116:119], a[68:71], v[32:35]
    ds_read_b64_tr_b16 a[168:169], v5 offset:2816
    ds_read_b64_tr_b16 a[170:171], v5 offset:3840
    v_mfma_f32_16x16x32_bf16 v[32:35], a[120:123], a[72:75], v[32:35]
    v_exp_f32 v49, v49
    v_mfma_f32_16x16x32_bf16 v[32:35], a[124:127], a[76:79], v[32:35]
    ds_read_b64_tr_b16 a[172:173], v5 offset:2848
    v_cvt_pk_bf16_f32 v72, v48, v49
    v_mfma_f32_16x16x32_bf16 v[36:39], a[128:131], a[64:67], v[84:87]
    v_exp_f32 v50, v50
    v_mfma_f32_16x16x32_bf16 v[36:39], a[132:135], a[68:71], v[36:39]
    ds_read_b64_tr_b16 a[174:175], v5 offset:3872
    v_add_u32 v5, s30, v3
    v_mfma_f32_16x16x32_bf16 v[36:39], a[136:139], a[72:75], v[36:39]
    v_exp_f32 v51, v51
    v_mfma_f32_16x16x32_bf16 v[36:39], a[140:143], a[76:79], v[36:39]
    ds_write_b64 v9, v[240:241] offset:128
    v_cvt_pk_bf16_f32 v73, v50, v51
    v_mfma_f32_16x16x32_bf16 a[176:179], a[196:199], v[56:59], a[176:179]
    v_exp_f32 v52, v52
    v_mfma_f32_16x16x32_bf16 a[180:183], a[196:199], v[60:63], a[180:183]
    s_waitcnt lgkmcnt(3)
    v_accvgpr_read_b32 v228, a20
    v_accvgpr_read_b32 v229, a21
    v_accvgpr_read_b32 v230, a22
    v_accvgpr_read_b32 v231, a23
    v_add_f32 v244, v244, v228
    v_add_f32 v245, v245, v229
    v_add_f32 v246, v246, v230
    v_mfma_f32_16x16x32_bf16 v[96:99], a[144:147], v[56:59], v[96:99]
    v_exp_f32 v53, v53
    v_mfma_f32_16x16x32_bf16 v[128:131], a[144:147], v[60:63], v[128:131]
    v_cvt_pk_bf16_f32 v74, v52, v53
    v_add_f32 v247, v247, v231
    v_mul_f32 v244, v244, v234
    v_mul_f32 v245, v245, v234
    v_mul_f32 v246, v246, v234
    v_mul_f32 v247, v247, v234
    v_cvt_pk_bf16_f32 v244, v244, v245
    v_cvt_pk_bf16_f32 v245, v246, v247
    v_mfma_f32_16x16x32_bf16 v[132:135], a[148:151], v[60:63], v[132:135]
    v_exp_f32 v54, v54
    v_mfma_f32_16x16x32_bf16 v[100:103], a[148:151], v[56:59], v[100:103]
    ds_write_b64 v9, v[244:245] offset:160
    v_mfma_f32_16x16x32_bf16 v[104:107], a[152:155], v[56:59], v[104:107]
    v_exp_f32 v55, v55
    v_mfma_f32_16x16x32_bf16 v[136:139], a[152:155], v[60:63], v[136:139]
    v_cvt_pk_bf16_f32 v75, v54, v55
    v_accvgpr_read_b32 v228, a24
    v_accvgpr_read_b32 v229, a25
    v_accvgpr_read_b32 v230, a26
    v_accvgpr_read_b32 v231, a27
    v_add_f32 v248, v248, v228
    v_add_f32 v249, v249, v229
    v_add_f32 v250, v250, v230
    v_mfma_f32_16x16x32_bf16 v[140:143], a[156:159], v[60:63], v[140:143]
    v_add_f32 v251, v251, v231
    v_mul_f32 v248, v248, v234
    v_mul_f32 v249, v249, v234
    v_mul_f32 v250, v250, v234
    v_mul_f32 v251, v251, v234
    v_cvt_pk_bf16_f32 v248, v248, v249
    v_cvt_pk_bf16_f32 v249, v250, v251
    v_mfma_f32_16x16x32_bf16 v[108:111], a[156:159], v[56:59], v[108:111]
    v_exp_f32 v32, v32
    v_mfma_f32_16x16x32_bf16 v[112:115], a[160:163], v[56:59], v[112:115]
    ds_write_b64 v9, v[248:249] offset:192
    v_mfma_f32_16x16x32_bf16 v[144:147], a[160:163], v[60:63], v[144:147]
    v_exp_f32 v33, v33
    v_mfma_f32_16x16x32_bf16 v[148:151], a[164:167], v[60:63], v[148:151]
    v_cvt_pk_bf16_f32 v64, v32, v33
    v_accvgpr_read_b32 v228, a28
    v_accvgpr_read_b32 v229, a29
    v_accvgpr_read_b32 v230, a30
    v_accvgpr_read_b32 v231, a31
    v_add_f32 v252, v252, v228
    v_add_f32 v253, v253, v229
    v_add_f32 v254, v254, v230
    v_mfma_f32_16x16x32_bf16 v[116:119], a[164:167], v[56:59], v[116:119]
    v_exp_f32 v34, v34
    v_mfma_f32_16x16x32_bf16 v[120:123], a[168:171], v[56:59], v[120:123]
    v_add_f32 v255, v255, v231
    v_mul_f32 v252, v252, v234
    v_mul_f32 v253, v253, v234
    v_mul_f32 v254, v254, v234
    v_mul_f32 v255, v255, v234
    v_cvt_pk_bf16_f32 v252, v252, v253
    v_mfma_f32_16x16x32_bf16 v[152:155], a[168:171], v[60:63], v[152:155]
    s_waitcnt lgkmcnt(1)
    v_exp_f32 v35, v35
    v_mfma_f32_16x16x32_bf16 v[156:159], a[172:175], v[60:63], v[156:159]
    v_cvt_pk_bf16_f32 v65, v34, v35
    v_cvt_pk_bf16_f32 v253, v254, v255
    v_mfma_f32_16x16x32_bf16 v[124:127], a[172:175], v[56:59], v[124:127]
    v_exp_f32 v36, v36
    v_mfma_f32_16x16x32_bf16 v[40:43], a[112:115], a[80:83], v[88:91]
    ds_read_b128 a[112:115], v4 offset:0
    ds_write_b64 v9, v[252:253] offset:224
    v_mfma_f32_16x16x32_bf16 v[40:43], a[116:119], a[84:87], v[40:43]
    v_exp_f32 v37, v37
    v_mfma_f32_16x16x32_bf16 v[40:43], a[120:123], a[88:91], v[40:43]
    ds_read_b128 a[116:119], v4 offset:256
    v_cvt_pk_bf16_f32 v66, v36, v37
    v_mfma_f32_16x16x32_bf16 v[40:43], a[124:127], a[92:95], v[40:43]
    v_exp_f32 v38, v38
    v_mfma_f32_16x16x32_bf16 v[44:47], a[128:131], a[80:83], v[88:91]
    ds_read_b128 a[120:123], v4 offset:512
    ds_read_b128 a[124:127], v4 offset:768
    v_mfma_f32_16x16x32_bf16 v[44:47], a[132:135], a[84:87], v[44:47]
    v_exp_f32 v39, v39
    v_mfma_f32_16x16x32_bf16 v[44:47], a[136:139], a[88:91], v[44:47]
    ds_read_b128 a[128:131], v4 offset:1024
    v_cvt_pk_bf16_f32 v67, v38, v39
    v_mfma_f32_16x16x32_bf16 v[44:47], a[140:143], a[92:95], v[44:47]
    ds_read_b128 a[132:135], v4 offset:1280
    ds_read_b128 a[136:139], v4 offset:1536
    v_mfma_f32_16x16x32_bf16 a[192:195], a[196:199], v[72:75], 0
    v_exp_f32 v40, v40
    v_mfma_f32_16x16x32_bf16 a[0:3], a[144:147], v[72:75], 0
    ds_read_b128 a[140:143], v4 offset:1792
    v_add_u32 v4, s30, v2
    v_mfma_f32_16x16x32_bf16 a[4:7], a[148:151], v[72:75], 0
    v_exp_f32 v41, v41
    v_mfma_f32_16x16x32_bf16 a[8:11], a[152:155], v[72:75], 0
    v_cvt_pk_bf16_f32 v68, v40, v41
    v_mfma_f32_16x16x32_bf16 a[12:15], a[156:159], v[72:75], 0
    v_exp_f32 v42, v42
    v_mfma_f32_16x16x32_bf16 a[16:19], a[160:163], v[72:75], 0
    v_mfma_f32_16x16x32_bf16 a[20:23], a[164:167], v[72:75], 0
    v_exp_f32 v43, v43
    v_mfma_f32_16x16x32_bf16 a[24:27], a[168:171], v[72:75], 0
    v_cvt_pk_bf16_f32 v69, v42, v43
    v_mfma_f32_16x16x32_bf16 a[28:31], a[172:175], v[72:75], 0
    s_waitcnt lgkmcnt(0)
    v_exp_f32 v44, v44
    v_mfma_f32_16x16x32_bf16 v[16:19], a[112:115], a[32:35], v[76:79]
    v_mfma_f32_16x16x32_bf16 v[16:19], a[116:119], a[36:39], v[16:19]
    v_exp_f32 v45, v45
    v_mfma_f32_16x16x32_bf16 v[16:19], a[120:123], a[40:43], v[16:19]
    v_cvt_pk_bf16_f32 v70, v44, v45
    v_mfma_f32_16x16x32_bf16 v[16:19], a[124:127], a[44:47], v[16:19]
    v_exp_f32 v46, v46
    v_mfma_f32_16x16x32_bf16 v[20:23], a[128:131], a[32:35], v[76:79]
    v_mfma_f32_16x16x32_bf16 v[20:23], a[132:135], a[36:39], v[20:23]
    v_exp_f32 v47, v47
    v_mfma_f32_16x16x32_bf16 v[20:23], a[136:139], a[40:43], v[20:23]
    v_cvt_pk_bf16_f32 v71, v46, v47
    v_mfma_f32_16x16x32_bf16 v[20:23], a[140:143], a[44:47], v[20:23]
    v_mfma_f32_16x16x32_bf16 v[24:27], a[112:115], a[48:51], v[80:83]
    v_exp_f32 v16, v16
    v_mfma_f32_16x16x32_bf16 v[24:27], a[116:119], a[52:55], v[24:27]
    s_waitcnt vmcnt(14)
    s_barrier
    v_mfma_f32_16x16x32_bf16 v[24:27], a[120:123], a[56:59], v[24:27]
    v_exp_f32 v17, v17
    v_mfma_f32_16x16x32_bf16 v[24:27], a[124:127], a[60:63], v[24:27]
    v_cvt_pk_bf16_f32 v56, v16, v17
    v_mfma_f32_16x16x32_bf16 v[28:31], a[128:131], a[48:51], v[80:83]
    v_exp_f32 v18, v18
    v_mfma_f32_16x16x32_bf16 v[28:31], a[132:135], a[52:55], v[28:31]
    buffer_load_dwordx4 v1, s[16:19], s64 offen nt lds
    v_mfma_f32_16x16x32_bf16 v[28:31], a[136:139], a[56:59], v[28:31]
    v_exp_f32 v19, v19
    v_mfma_f32_16x16x32_bf16 v[28:31], a[140:143], a[60:63], v[28:31]
    v_cvt_pk_bf16_f32 v57, v18, v19
    v_mfma_f32_16x16x32_bf16 a[184:187], a[196:199], v[64:67], a[184:187]
    v_exp_f32 v20, v20
    v_mfma_f32_16x16x32_bf16 a[188:191], a[196:199], v[68:71], a[188:191]
    buffer_load_dwordx4 v1, s[16:19], s64 offen offset:1024 nt lds
    v_mfma_f32_16x16x32_bf16 v[160:163], a[144:147], v[64:67], v[160:163]
    v_exp_f32 v21, v21
    v_mfma_f32_16x16x32_bf16 v[192:195], a[144:147], v[68:71], v[192:195]
    ds_read_b64_tr_b16 a[144:145], v5 offset:2048
    v_cvt_pk_bf16_f32 v58, v20, v21
    v_mfma_f32_16x16x32_bf16 v[196:199], a[148:151], v[68:71], v[196:199]
    v_exp_f32 v22, v22
    v_mfma_f32_16x16x32_bf16 v[164:167], a[148:151], v[64:67], v[164:167]
    buffer_load_dwordx4 v1, s[20:23], s65 offen offset:2048 nt lds
    v_mfma_f32_16x16x32_bf16 v[168:171], a[152:155], v[64:67], v[168:171]
    v_exp_f32 v23, v23
    v_mfma_f32_16x16x32_bf16 v[200:203], a[152:155], v[68:71], v[200:203]
    ds_read_b64_tr_b16 a[146:147], v5 offset:3072
    v_cvt_pk_bf16_f32 v59, v22, v23
    v_mfma_f32_16x16x32_bf16 v[204:207], a[156:159], v[68:71], v[204:207]
    buffer_load_dwordx4 v1, s[20:23], s65 offen offset:3072 nt lds
    v_mfma_f32_16x16x32_bf16 v[172:175], a[156:159], v[64:67], v[172:175]
    s_mov_b32 s65, s64
    v_exp_f32 v24, v24
    v_mfma_f32_16x16x32_bf16 v[176:179], a[160:163], v[64:67], v[176:179]
    s_add_u32 s31, s31, 8192
    ds_read_b64_tr_b16 a[148:149], v5 offset:2080
    ds_read_b64_tr_b16 a[150:151], v5 offset:3104
    v_mfma_f32_16x16x32_bf16 v[208:211], a[160:163], v[68:71], v[208:211]
    s_or_b32 s31, s31, s67
    v_exp_f32 v25, v25
    v_mfma_f32_16x16x32_bf16 v[212:215], a[164:167], v[68:71], v[212:215]
    s_xor_b32 s64, s31, s66
    ds_read_b64_tr_b16 a[152:153], v5 offset:2304
    v_cvt_pk_bf16_f32 v60, v24, v25
    v_mfma_f32_16x16x32_bf16 v[180:183], a[164:167], v[64:67], v[180:183]
    s_add_u32 m0, s30, s32
    v_exp_f32 v26, v26
    v_mfma_f32_16x16x32_bf16 v[184:187], a[168:171], v[64:67], v[184:187]
    s_add_u32 s30, s30, 16512
    ds_read_b64_tr_b16 a[154:155], v5 offset:3328
    ds_read_b64_tr_b16 a[156:157], v5 offset:2336
    v_mfma_f32_16x16x32_bf16 v[216:219], a[168:171], v[68:71], v[216:219]
    s_cmp_eq_u32 s30, 82560
    v_exp_f32 v27, v27
    v_mfma_f32_16x16x32_bf16 v[220:223], a[172:175], v[68:71], v[220:223]
    s_cselect_b32 s30, 0, s30
    ds_read_b64_tr_b16 a[158:159], v5 offset:3360
    v_cvt_pk_bf16_f32 v61, v26, v27
    v_mfma_f32_16x16x32_bf16 v[188:191], a[172:175], v[64:67], v[188:191]
    v_exp_f32 v28, v28
    v_mfma_f32_16x16x32_bf16 v[32:35], a[112:115], a[64:67], v[84:87]
    ds_read_b64_tr_b16 a[160:161], v5 offset:2560
    ds_read_b64_tr_b16 a[162:163], v5 offset:3584
    v_mfma_f32_16x16x32_bf16 v[32:35], a[116:119], a[68:71], v[32:35]
    v_exp_f32 v29, v29
    v_mfma_f32_16x16x32_bf16 v[32:35], a[120:123], a[72:75], v[32:35]
    ds_read_b64_tr_b16 a[164:165], v5 offset:2592
    v_cvt_pk_bf16_f32 v62, v28, v29
    v_mfma_f32_16x16x32_bf16 v[32:35], a[124:127], a[76:79], v[32:35]
    v_exp_f32 v30, v30
    v_mfma_f32_16x16x32_bf16 v[36:39], a[128:131], a[64:67], v[84:87]
    ds_read_b64_tr_b16 a[166:167], v5 offset:3616
    ds_read_b64_tr_b16 a[168:169], v5 offset:2816
    v_mfma_f32_16x16x32_bf16 v[36:39], a[132:135], a[68:71], v[36:39]
    v_exp_f32 v31, v31
    v_mfma_f32_16x16x32_bf16 v[36:39], a[136:139], a[72:75], v[36:39]
    ds_read_b64_tr_b16 a[170:171], v5 offset:3840
    v_cvt_pk_bf16_f32 v63, v30, v31
    v_mfma_f32_16x16x32_bf16 v[36:39], a[140:143], a[76:79], v[36:39]
    ds_read_b64_tr_b16 a[172:173], v5 offset:2848
    ds_read_b64_tr_b16 a[174:175], v5 offset:3872
    v_mfma_f32_16x16x32_bf16 v[40:43], a[112:115], a[80:83], v[88:91]
    v_exp_f32 v32, v32
    v_mfma_f32_16x16x32_bf16 v[40:43], a[116:119], a[84:87], v[40:43]
    ds_read_b128 a[112:115], v4 offset:0
    ds_read_b128 a[116:119], v4 offset:256
    v_mfma_f32_16x16x32_bf16 v[40:43], a[120:123], a[88:91], v[40:43]
    v_exp_f32 v33, v33
    v_mfma_f32_16x16x32_bf16 v[40:43], a[124:127], a[92:95], v[40:43]
    ds_read_b128 a[120:123], v4 offset:512
    v_cvt_pk_bf16_f32 v64, v32, v33
    v_mfma_f32_16x16x32_bf16 v[44:47], a[128:131], a[80:83], v[88:91]
    v_exp_f32 v34, v34
    v_mfma_f32_16x16x32_bf16 v[44:47], a[132:135], a[84:87], v[44:47]
    ds_read_b128 a[124:127], v4 offset:768
    ds_read_b128 a[128:131], v4 offset:1024
    v_mfma_f32_16x16x32_bf16 v[44:47], a[136:139], a[88:91], v[44:47]
    v_exp_f32 v35, v35
    v_mfma_f32_16x16x32_bf16 v[44:47], a[140:143], a[92:95], v[44:47]
    ds_read_b128 a[132:135], v4 offset:1280
    v_cvt_pk_bf16_f32 v65, v34, v35
    v_mfma_f32_16x16x32_bf16 a[176:179], a[196:199], v[56:59], a[176:179]
    v_exp_f32 v36, v36
    v_mfma_f32_16x16x32_bf16 a[180:183], a[196:199], v[60:63], a[180:183]
    s_waitcnt lgkmcnt(4)
    ds_read_b128 a[136:139], v4 offset:1536
    ds_read_b128 a[140:143], v4 offset:1792
    v_mfma_f32_16x16x32_bf16 v[96:99], a[144:147], v[56:59], v[96:99]
    v_exp_f32 v37, v37
    v_mfma_f32_16x16x32_bf16 v[128:131], a[144:147], v[60:63], v[128:131]
    v_cvt_pk_bf16_f32 v66, v36, v37
    v_mfma_f32_16x16x32_bf16 v[132:135], a[148:151], v[60:63], v[132:135]
    v_exp_f32 v38, v38
    v_mfma_f32_16x16x32_bf16 v[100:103], a[148:151], v[56:59], v[100:103]
    v_add_u32 v5, s30, v3
    v_mfma_f32_16x16x32_bf16 v[104:107], a[152:155], v[56:59], v[104:107]
    v_exp_f32 v39, v39
    v_mfma_f32_16x16x32_bf16 v[136:139], a[152:155], v[60:63], v[136:139]
    v_cvt_pk_bf16_f32 v67, v38, v39
    v_mfma_f32_16x16x32_bf16 v[140:143], a[156:159], v[60:63], v[140:143]
    v_add_u32 v4, s30, v2
    v_mfma_f32_16x16x32_bf16 v[108:111], a[156:159], v[56:59], v[108:111]
    v_exp_f32 v40, v40
    v_mfma_f32_16x16x32_bf16 v[112:115], a[160:163], v[56:59], v[112:115]
    v_mfma_f32_16x16x32_bf16 v[144:147], a[160:163], v[60:63], v[144:147]
    v_exp_f32 v41, v41
    v_mfma_f32_16x16x32_bf16 v[148:151], a[164:167], v[60:63], v[148:151]
    v_cvt_pk_bf16_f32 v68, v40, v41
    v_mfma_f32_16x16x32_bf16 v[116:119], a[164:167], v[56:59], v[116:119]
    v_exp_f32 v42, v42
    v_mfma_f32_16x16x32_bf16 v[120:123], a[168:171], v[56:59], v[120:123]
    v_mfma_f32_16x16x32_bf16 v[152:155], a[168:171], v[60:63], v[152:155]
    v_exp_f32 v43, v43
    v_mfma_f32_16x16x32_bf16 v[156:159], a[172:175], v[60:63], v[156:159]
    v_cvt_pk_bf16_f32 v69, v42, v43
    v_mfma_f32_16x16x32_bf16 v[124:127], a[172:175], v[56:59], v[124:127]
    v_exp_f32 v44, v44
    v_mfma_f32_16x16x32_bf16 v[16:19], a[112:115], a[32:35], v[76:79]
    v_mfma_f32_16x16x32_bf16 v[16:19], a[116:119], a[36:39], v[16:19]
    s_waitcnt lgkmcnt(0)
    v_exp_f32 v45, v45
    v_mfma_f32_16x16x32_bf16 v[16:19], a[120:123], a[40:43], v[16:19]
    v_cvt_pk_bf16_f32 v70, v44, v45
    v_mfma_f32_16x16x32_bf16 v[16:19], a[124:127], a[44:47], v[16:19]
    v_exp_f32 v46, v46
    v_mfma_f32_16x16x32_bf16 v[20:23], a[128:131], a[32:35], v[76:79]
    v_mfma_f32_16x16x32_bf16 v[20:23], a[132:135], a[36:39], v[20:23]
    v_exp_f32 v47, v47
    v_mfma_f32_16x16x32_bf16 v[20:23], a[136:139], a[40:43], v[20:23]
    v_cvt_pk_bf16_f32 v71, v46, v47
    v_mfma_f32_16x16x32_bf16 v[20:23], a[140:143], a[44:47], v[20:23]
    s_branch L_B0
    .p2align 12
L_pa5:
    s_branch L_wa
L_pb5:
    s_branch L_wb1
L_pg5:
L_Ax:
    v_mfma_f32_16x16x32_bf16 v[24:27], a[112:115], a[48:51], v[80:83]
    v_exp_f32 v16, v16
    v_mfma_f32_16x16x32_bf16 v[24:27], a[116:119], a[52:55], v[24:27]
    s_waitcnt vmcnt(20) lgkmcnt(0)
    s_barrier
    v_mfma_f32_16x16x32_bf16 v[24:27], a[120:123], a[56:59], v[24:27]
    ds_read_b128 a[200:203], v15 offset:0
    ds_read_b128 a[204:207], v15 offset:256
    ds_read_b128 a[32:35], v6 offset:0
    ds_read_b128 a[36:39], v6 offset:256
    ds_read_b128 a[40:43], v6 offset:512
    ds_read_b128 a[44:47], v6 offset:768
    v_exp_f32 v17, v17
    v_mfma_f32_16x16x32_bf16 v[24:27], a[124:127], a[60:63], v[24:27]
    ds_read_b128 a[208:211], v15 offset:512
    v_cvt_pk_bf16_f32 v56, v16, v17
    v_mfma_f32_16x16x32_bf16 v[28:31], a[128:131], a[48:51], v[80:83]
    v_exp_f32 v18, v18
    v_mfma_f32_16x16x32_bf16 v[28:31], a[132:135], a[52:55], v[28:31]
    buffer_load_dwordx4 v1, s[16:19], s64 offen nt lds
    v_mfma_f32_16x16x32_bf16 v[28:31], a[136:139], a[56:59], v[28:31]
    v_exp_f32 v19, v19
    v_mfma_f32_16x16x32_bf16 v[28:31], a[140:143], a[60:63], v[28:31]
    ds_read_b128 a[212:215], v15 offset:768
    v_cvt_pk_bf16_f32 v57, v18, v19
    v_mfma_f32_16x16x32_bf16 a[184:187], a[196:199], v[64:67], a[184:187]
    v_exp_f32 v20, v20
    v_mfma_f32_16x16x32_bf16 a[188:191], a[196:199], v[68:71], a[188:191]
    buffer_load_dwordx4 v1, s[16:19], s64 offen offset:1024 nt lds
    v_mfma_f32_16x16x32_bf16 v[160:163], a[144:147], v[64:67], v[160:163]
    v_exp_f32 v21, v21
    v_mfma_f32_16x16x32_bf16 v[192:195], a[144:147], v[68:71], v[192:195]
    ds_read_b64_tr_b16 a[144:145], v5 offset:2048
    v_cvt_pk_bf16_f32 v58, v20, v21
    v_mfma_f32_16x16x32_bf16 v[196:199], a[148:151], v[68:71], v[196:199]
    v_exp_f32 v22, v22
    v_mfma_f32_16x16x32_bf16 v[164:167], a[148:151], v[64:67], v[164:167]
    buffer_load_dwordx4 v1, s[20:23], s65 offen offset:2048 nt lds
    v_mfma_f32_16x16x32_bf16 v[168:171], a[152:155], v[64:67], v[168:171]
    v_exp_f32 v23, v23
    v_mfma_f32_16x16x32_bf16 v[200:203], a[152:155], v[68:71], v[200:203]
    ds_read_b64_tr_b16 a[146:147], v5 offset:3072
    v_cvt_pk_bf16_f32 v59, v22, v23
    v_mfma_f32_16x16x32_bf16 v[204:207], a[156:159], v[68:71], v[204:207]
    buffer_load_dwordx4 v1, s[20:23], s65 offen offset:3072 nt lds
    v_mfma_f32_16x16x32_bf16 v[172:175], a[156:159], v[64:67], v[172:175]
    s_mov_b32 s65, s64
    v_exp_f32 v24, v24
    v_mfma_f32_16x16x32_bf16 v[176:179], a[160:163], v[64:67], v[176:179]
    s_add_u32 s31, s31, 8192
    ds_read_b64_tr_b16 a[148:149], v5 offset:2080
    ds_read_b64_tr_b16 a[150:151], v5 offset:3104
    v_mfma_f32_16x16x32_bf16 v[208:211], a[160:163], v[68:71], v[208:211]
    s_or_b32 s31, s31, s67
    v_exp_f32 v25, v25
    v_mfma_f32_16x16x32_bf16 v[212:215], a[164:167], v[68:71], v[212:215]
    s_xor_b32 s64, s31, s66
    ds_read_b64_tr_b16 a[152:153], v5 offset:2304
    v_cvt_pk_bf16_f32 v60, v24, v25
    v_mfma_f32_16x16x32_bf16 v[180:183], a[164:167], v[64:67], v[180:183]
    s_add_u32 m0, s30, s32
    v_exp_f32 v26, v26
    v_mfma_f32_16x16x32_bf16 v[184:187], a[168:171], v[64:67], v[184:187]
    s_add_u32 s30, s30, 16512
    ds_read_b64_tr_b16 a[154:155], v5 offset:3328
    ds_read_b64_tr_b16 a[156:157], v5 offset:2336
    v_mfma_f32_16x16x32_bf16 v[216:219], a[168:171], v[68:71], v[216:219]
    s_cmp_eq_u32 s30, 82560
    v_exp_f32 v27, v27
    v_mfma_f32_16x16x32_bf16 v[220:223], a[172:175], v[68:71], v[220:223]
    s_cselect_b32 s30, 0, s30
    ds_read_b64_tr_b16 a[158:159], v5 offset:3360
    v_cvt_pk_bf16_f32 v61, v26, v27
    v_mfma_f32_16x16x32_bf16 v[188:191], a[172:175], v[64:67], v[188:191]
    v_exp_f32 v28, v28
    v_mfma_f32_16x16x32_bf16 v[32:35], a[112:115], a[64:67], v[84:87]
    ds_read_b64_tr_b16 a[160:161], v5 offset:2560
    ds_read_b64_tr_b16 a[162:163], v5 offset:3584
    v_mfma_f32_16x16x32_bf16 v[32:35], a[116:119], a[68:71], v[32:35]
    v_exp_f32 v29, v29
    v_mfma_f32_16x16x32_bf16 v[32:35], a[120:123], a[72:75], v[32:35]
    ds_read_b64_tr_b16 a[164:165], v5 offset:2592
    v_cvt_pk_bf16_f32 v62, v28, v29
    v_mfma_f32_16x16x32_bf16 v[32:35], a[124:127], a[76:79], v[32:35]
    v_exp_f32 v30, v30
    v_mfma_f32_16x16x32_bf16 v[36:39], a[128:131], a[64:67], v[84:87]
    ds_read_b64_tr_b16 a[166:167], v5 offset:3616
    ds_read_b64_tr_b16 a[168:169], v5 offset:2816
    v_mfma_f32_16x16x32_bf16 v[36:39], a[132:135], a[68:71], v[36:39]
    v_exp_f32 v31, v31
    v_mfma_f32_16x16x32_bf16 v[36:39], a[136:139], a[72:75], v[36:39]
    ds_read_b64_tr_b16 a[170:171], v5 offset:3840
    v_cvt_pk_bf16_f32 v63, v30, v31
    v_mfma_f32_16x16x32_bf16 v[36:39], a[140:143], a[76:79], v[36:39]
    ds_read_b64_tr_b16 a[172:173], v5 offset:2848
    ds_read_b64_tr_b16 a[174:175], v5 offset:3872
    v_mfma_f32_16x16x32_bf16 v[40:43], a[112:115], a[80:83], v[88:91]
    v_exp_f32 v32, v32
    v_mfma_f32_16x16x32_bf16 v[40:43], a[116:119], a[84:87], v[40:43]
    ds_read_b128 a[112:115], v4 offset:0
    ds_read_b128 a[116:119], v4 offset:256
    v_mfma_f32_16x16x32_bf16 v[40:43], a[120:123], a[88:91], v[40:43]
    v_exp_f32 v33, v33
    v_mfma_f32_16x16x32_bf16 v[40:43], a[124:127], a[92:95], v[40:43]
    ds_read_b128 a[120:123], v4 offset:512
    v_cvt_pk_bf16_f32 v64, v32, v33
    v_mfma_f32_16x16x32_bf16 v[44:47], a[128:131], a[80:83], v[88:91]
    v_exp_f32 v34, v34
    v_mfma_f32_16x16x32_bf16 v[44:47], a[132:135], a[84:87], v[44:47]
    ds_read_b128 a[124:127], v4 offset:768
    ds_read_b128 a[128:131], v4 offset:1024
    v_mfma_f32_16x16x32_bf16 v[44:47], a[136:139], a[88:91], v[44:47]
    v_exp_f32 v35, v35
    v_mfma_f32_16x16x32_bf16 v[44:47], a[140:143], a[92:95], v[44:47]
    s_waitcnt lgkmcnt(5)
    ds_read_b128 a[132:135], v4 offset:1280
    v_cvt_pk_bf16_f32 v65, v34, v35
    v_mfma_f32_16x16x32_bf16 v[76:79], a[200:203], a[32:35], 0
    v_accvgpr_read_b32 v10, a226
    v_mfma_f32_16x16x32_bf16 v[76:79], a[204:207], a[36:39], v[76:79]
    v_subrev_u32 v10, 0, v10
    v_mfma_f32_16x16x32_bf16 v[76:79], a[208:211], a[40:43], v[76:79]
    s_mov_b32 s38, 0
    v_mfma_f32_16x16x32_bf16 v[76:79], a[212:215], a[44:47], v[76:79]
    s_mov_b32 s33, 4
    v_mfma_f32_16x16x32_bf16 a[176:179], a[196:199], v[56:59], a[176:179]
    v_exp_f32 v36, v36
    v_mfma_f32_16x16x32_bf16 a[180:183], a[196:199], v[60:63], a[180:183]
    ds_read_b128 a[136:139], v4 offset:1536
    ds_read_b128 a[140:143], v4 offset:1792
    v_mfma_f32_16x16x32_bf16 v[96:99], a[144:147], v[56:59], v[96:99]
    v_exp_f32 v37, v37
    v_mfma_f32_16x16x32_bf16 v[128:131], a[144:147], v[60:63], v[128:131]
    ds_read_b128 a[48:51], v6 offset:4352
    v_cvt_pk_bf16_f32 v66, v36, v37
    v_mfma_f32_16x16x32_bf16 v[132:135], a[148:151], v[60:63], v[132:135]
    v_exp_f32 v38, v38
    v_mfma_f32_16x16x32_bf16 v[100:103], a[148:151], v[56:59], v[100:103]
    ds_read_b128 a[52:55], v6 offset:4608
    v_add_u32 v5, s30, v3
    v_mfma_f32_16x16x32_bf16 v[104:107], a[152:155], v[56:59], v[104:107]
    v_exp_f32 v39, v39
    v_accvgpr_read_b32 v225, a176
    v_mfma_f32_16x16x32_bf16 v[136:139], a[152:155], v[60:63], v[136:139]
    ds_read_b128 a[56:59], v6 offset:4864
    v_cvt_pk_bf16_f32 v67, v38, v39
    v_mfma_f32_16x16x32_bf16 v[140:143], a[156:159], v[60:63], v[140:143]
    ds_read_b128 a[60:63], v6 offset:5120
    v_add_u32 v4, s30, v2
    v_mfma_f32_16x16x32_bf16 v[108:111], a[156:159], v[56:59], v[108:111]
    v_exp_f32 v40, v40
    v_accvgpr_read_b32 v227, a180
    v_rcp_f32 v224, v225
    v_mfma_f32_16x16x32_bf16 v[112:115], a[160:163], v[56:59], v[112:115]
    ds_read_b128 a[96:99], v7 offset:0
    v_sub_f32 v76, 0, v76
    v_mfma_f32_16x16x32_bf16 v[144:147], a[160:163], v[60:63], v[144:147]
    v_exp_f32 v41, v41
    v_add_f32 v14, v14, v225
    v_rcp_f32 v226, v227
    v_mfma_f32_16x16x32_bf16 v[148:151], a[164:167], v[60:63], v[148:151]
    ds_read_b128 a[100:103], v7 offset:256
    v_cvt_pk_bf16_f32 v68, v40, v41
    v_mfma_f32_16x16x32_bf16 v[116:119], a[164:167], v[56:59], v[116:119]
    v_exp_f32 v42, v42
    v_add_f32 v14, v14, v227
    v_mfma_f32_16x16x32_bf16 v[120:123], a[168:171], v[56:59], v[120:123]
    ds_read_b128 a[104:107], v7 offset:512
    v_sub_f32 v77, 0, v77
    v_mfma_f32_16x16x32_bf16 v[152:155], a[168:171], v[60:63], v[152:155]
    v_exp_f32 v43, v43
    v_mfma_f32_16x16x32_bf16 v[156:159], a[172:175], v[60:63], v[156:159]
    ds_read_b128 a[108:111], v7 offset:768
    v_cvt_pk_bf16_f32 v69, v42, v43
    v_mfma_f32_16x16x32_bf16 v[124:127], a[172:175], v[56:59], v[124:127]
    s_waitcnt lgkmcnt(3)
    v_exp_f32 v44, v44
    v_mfma_f32_16x16x32_bf16 v[80:83], a[200:203], a[48:51], 0
    ds_read_b128 a[64:67], v6 offset:8704
    v_sub_f32 v78, 0, v78
    v_mfma_f32_16x16x32_bf16 v[80:83], a[204:207], a[52:55], v[80:83]
    ds_read_b128 a[68:71], v6 offset:8960
    v_sub_f32 v79, 0, v79
    s_cbranch_vccnz L_fix0a0
L_fix0a0r:
    v_mfma_f32_16x16x32_bf16 v[80:83], a[208:211], a[56:59], v[80:83]
    v_pk_mul_f32 v[96:97], v[96:97], v[224:225] op_sel_hi:[1,0]
    v_pk_mul_f32 v[98:99], v[98:99], v[224:225] op_sel_hi:[1,0]
    v_pk_mul_f32 v[128:129], v[128:129], v[226:227] op_sel_hi:[1,0]
    v_pk_mul_f32 v[130:131], v[130:131], v[226:227] op_sel_hi:[1,0]
    v_pk_mul_f32 v[100:101], v[100:101], v[224:225] op_sel_hi:[1,0]
    v_pk_mul_f32 v[102:103], v[102:103], v[224:225] op_sel_hi:[1,0]
    v_pk_mul_f32 v[132:133], v[132:133], v[226:227] op_sel_hi:[1,0]
    v_pk_mul_f32 v[134:135], v[134:135], v[226:227] op_sel_hi:[1,0]
    v_pk_mul_f32 v[104:105], v[104:105], v[224:225] op_sel_hi:[1,0]
    v_pk_mul_f32 v[106:107], v[106:107], v[224:225] op_sel_hi:[1,0]
    v_pk_mul_f32 v[136:137], v[136:137], v[226:227] op_sel_hi:[1,0]
    v_pk_mul_f32 v[138:139], v[138:139], v[226:227] op_sel_hi:[1,0]
    v_pk_mul_f32 v[108:109], v[108:109], v[224:225] op_sel_hi:[1,0]
    v_pk_mul_f32 v[110:111], v[110:111], v[224:225] op_sel_hi:[1,0]
    v_pk_mul_f32 v[140:141], v[140:141], v[226:227] op_sel_hi:[1,0]
    v_pk_mul_f32 v[142:143], v[142:143], v[226:227] op_sel_hi:[1,0]
    v_pk_mul_f32 v[112:113], v[112:113], v[224:225] op_sel_hi:[1,0]
    v_pk_mul_f32 v[114:115], v[114:115], v[224:225] op_sel_hi:[1,0]
    v_pk_mul_f32 v[144:145], v[144:145], v[226:227] op_sel_hi:[1,0]
    v_pk_mul_f32 v[146:147], v[146:147], v[226:227] op_sel_hi:[1,0]
    v_pk_mul_f32 v[116:117], v[116:117], v[224:225] op_sel_hi:[1,0]
    v_pk_mul_f32 v[118:119], v[118:119], v[224:225] op_sel_hi:[1,0]
    v_pk_mul_f32 v[148:149], v[148:149], v[226:227] op_sel_hi:[1,0]
    v_pk_mul_f32 v[150:151], v[150:151], v[226:227] op_sel_hi:[1,0]
    v_pk_mul_f32 v[120:121], v[120:121], v[224:225] op_sel_hi:[1,0]
    v_pk_mul_f32 v[122:123], v[122:123], v[224:225] op_sel_hi:[1,0]
    v_pk_mul_f32 v[152:153], v[152:153], v[226:227] op_sel_hi:[1,0]
    v_pk_mul_f32 v[154:155], v[154:155], v[226:227] op_sel_hi:[1,0]
    v_pk_mul_f32 v[124:125], v[124:125], v[224:225] op_sel_hi:[1,0]
    v_pk_mul_f32 v[126:127], v[126:127], v[224:225] op_sel_hi:[1,0]
    v_pk_mul_f32 v[156:157], v[156:157], v[226:227] op_sel_hi:[1,0]
    v_pk_mul_f32 v[158:159], v[158:159], v[226:227] op_sel_hi:[1,0]
    v_cvt_pk_bf16_f32 v96, v96, v97
    v_cvt_pk_bf16_f32 v97, v98, v99
    v_mfma_f32_16x16x32_bf16 v[80:83], a[212:215], a[60:63], v[80:83]
    ds_write_b64 v8, v[96:97] offset:0
    v_cvt_pk_bf16_f32 v128, v128, v129
    v_cvt_pk_bf16_f32 v129, v130, v131
    v_mfma_f32_16x16x32_bf16 v[16:19], a[112:115], a[32:35], v[76:79]
    ds_write_b64 v8, v[128:129] offset:4352
    v_cvt_pk_bf16_f32 v100, v100, v101
    v_mfma_f32_16x16x32_bf16 v[16:19], a[116:119], a[36:39], v[16:19]
    v_exp_f32 v45, v45
    v_cvt_pk_bf16_f32 v101, v102, v103
    v_mfma_f32_16x16x32_bf16 v[16:19], a[120:123], a[40:43], v[16:19]
    ds_read_b128 a[72:75], v6 offset:9216
    v_cvt_pk_bf16_f32 v70, v44, v45
    v_mfma_f32_16x16x32_bf16 v[16:19], a[124:127], a[44:47], v[16:19]
    ds_write_b64 v8, v[100:101] offset:32
    v_exp_f32 v46, v46
    v_cvt_pk_bf16_f32 v132, v132, v133
    v_mfma_f32_16x16x32_bf16 v[20:23], a[128:131], a[32:35], v[76:79]
    ds_read_b128 a[76:79], v6 offset:9472
    v_sub_f32 v80, 0, v80
    v_mfma_f32_16x16x32_bf16 v[20:23], a[132:135], a[36:39], v[20:23]
    v_exp_f32 v47, v47
    v_cvt_pk_bf16_f32 v133, v134, v135
    v_mfma_f32_16x16x32_bf16 v[20:23], a[136:139], a[40:43], v[20:23]
    ds_read_b128 a[80:83], v6 offset:13056
    v_cvt_pk_bf16_f32 v71, v46, v47
    v_mfma_f32_16x16x32_bf16 v[20:23], a[140:143], a[44:47], v[20:23]
    ds_read_b128 a[84:87], v6 offset:13312
    v_sub_f32 v81, 0, v81
    v_mfma_f32_16x16x32_bf16 v[92:95], a[200:203], a[96:99], 0
    s_waitcnt lgkmcnt(5)
    ds_read_b128 a[88:91], v6 offset:13568
    v_sub_f32 v82, 0, v82
    v_mfma_f32_16x16x32_bf16 v[92:95], a[204:207], a[100:103], v[92:95]
    ds_read_b128 a[92:95], v6 offset:13824
    v_sub_f32 v83, 0, v83
    s_cbranch_vccnz L_fix0a1
L_fix0a1r:
    v_mfma_f32_16x16x32_bf16 v[92:95], a[208:211], a[104:107], v[92:95]
    ds_write_b64 v8, v[132:133] offset:4384
    v_cvt_pk_bf16_f32 v104, v104, v105
    v_cvt_pk_bf16_f32 v105, v106, v107
    v_mfma_f32_16x16x32_bf16 v[92:95], a[212:215], a[108:111], v[92:95]
    ds_write_b64 v8, v[104:105] offset:64
    v_cvt_pk_bf16_f32 v136, v136, v137
    v_mfma_f32_16x16x32_bf16 v[24:27], a[112:115], a[48:51], v[80:83]
    v_exp_f32 v16, v16
    v_cvt_pk_bf16_f32 v137, v138, v139
    v_mfma_f32_16x16x32_bf16 v[24:27], a[116:119], a[52:55], v[24:27]
    ds_write_b64 v8, v[136:137] offset:4416
    v_cvt_pk_bf16_f32 v108, v108, v109
    v_mfma_f32_16x16x32_bf16 v[24:27], a[120:123], a[56:59], v[24:27]
    v_exp_f32 v17, v17
    v_cvt_pk_bf16_f32 v109, v110, v111
    v_mfma_f32_16x16x32_bf16 v[24:27], a[124:127], a[60:63], v[24:27]
    ds_write_b64 v8, v[108:109] offset:96
    v_cvt_pk_bf16_f32 v56, v16, v17
    v_mfma_f32_16x16x32_bf16 v[28:31], a[128:131], a[48:51], v[80:83]
    v_exp_f32 v18, v18
    v_mfma_f32_16x16x32_bf16 v[28:31], a[132:135], a[52:55], v[28:31]
    v_sub_f32 v92, 0, v92
    v_cvt_pk_bf16_f32 v140, v140, v141
    v_cvt_pk_bf16_f32 v141, v142, v143
    v_mfma_f32_16x16x32_bf16 v[28:31], a[136:139], a[56:59], v[28:31]
    v_exp_f32 v19, v19
    v_mfma_f32_16x16x32_bf16 v[28:31], a[140:143], a[60:63], v[28:31]
    ds_write_b64 v8, v[140:141] offset:4448
    v_cvt_pk_bf16_f32 v57, v18, v19
    v_mfma_f32_16x16x32_bf16 v[84:87], a[200:203], a[64:67], 0
    v_sub_f32 v93, 0, v93
    v_cvt_pk_bf16_f32 v112, v112, v113
    v_cvt_pk_bf16_f32 v113, v114, v115
    v_mfma_f32_16x16x32_bf16 v[84:87], a[204:207], a[68:71], v[84:87]
    s_waitcnt lgkmcnt(2)
    ds_write_b64 v8, v[112:113] offset:128
    v_sub_f32 v94, 0, v94
    v_mfma_f32_16x16x32_bf16 v[84:87], a[208:211], a[72:75], v[84:87]
    v_sub_f32 v95, 0, v95
    v_cvt_pk_bf16_f32 v144, v144, v145
    v_cvt_pk_bf16_f32 v145, v146, v147
    s_cbranch_vccnz L_fix0c
L_fix0cr:
    v_mfma_f32_16x16x32_bf16 v[84:87], a[212:215], a[76:79], v[84:87]
    ds_write_b64 v8, v[144:145] offset:4480
    v_cvt_pk_bf16_f32 v116, v116, v117
    v_mfma_f32_16x16x32_bf16 a[184:187], a[196:199], v[64:67], a[184:187]
    v_exp_f32 v20, v20
    v_cvt_pk_bf16_f32 v117, v118, v119
    v_mfma_f32_16x16x32_bf16 a[188:191], a[196:199], v[68:71], a[188:191]
    s_waitcnt vmcnt(18) lgkmcnt(0)
    s_barrier
    ds_write_b64 v8, v[116:117] offset:160
    v_cvt_pk_bf16_f32 v148, v148, v149
    v_mfma_f32_16x16x32_bf16 v[160:163], a[144:147], v[64:67], v[160:163]
    v_exp_f32 v21, v21
    v_cvt_pk_bf16_f32 v149, v150, v151
    v_mfma_f32_16x16x32_bf16 v[192:195], a[144:147], v[68:71], v[192:195]
    ds_write_b128 v12, a[16:19] offset:4128
    v_cvt_pk_bf16_f32 v58, v20, v21
    v_mfma_f32_16x16x32_bf16 v[196:199], a[148:151], v[68:71], v[196:199]
    v_exp_f32 v22, v22
    v_mfma_f32_16x16x32_bf16 v[164:167], a[148:151], v[64:67], v[164:167]
    ds_write_b128 v12, a[20:23] offset:5152
    v_mfma_f32_16x16x32_bf16 v[168:171], a[152:155], v[64:67], v[168:171]
    v_exp_f32 v23, v23
    v_mfma_f32_16x16x32_bf16 v[200:203], a[152:155], v[68:71], v[200:203]
    ds_write_b128 v12, a[24:27] offset:6176
    v_cvt_pk_bf16_f32 v59, v22, v23
    v_mfma_f32_16x16x32_bf16 v[204:207], a[156:159], v[68:71], v[204:207]
    ds_write_b128 v12, a[28:31] offset:7200
    v_mfma_f32_16x16x32_bf16 v[172:175], a[156:159], v[64:67], v[172:175]
    v_exp_f32 v24, v24
    v_mfma_f32_16x16x32_bf16 v[176:179], a[160:163], v[64:67], v[176:179]
    ds_write_b32 v13, a192 offset:64
    ds_read_b64_tr_b16 a[144:145], v5 offset:2048
    v_accvgpr_read_b32 v225, a184
    v_mfma_f32_16x16x32_bf16 v[208:211], a[160:163], v[68:71], v[208:211]
    v_exp_f32 v25, v25
    v_mfma_f32_16x16x32_bf16 v[212:215], a[164:167], v[68:71], v[212:215]
    ds_read_b64_tr_b16 a[146:147], v5 offset:3072
    v_cvt_pk_bf16_f32 v60, v24, v25
    v_mfma_f32_16x16x32_bf16 v[180:183], a[164:167], v[64:67], v[180:183]
    ds_read_b64_tr_b16 a[164:165], v5 offset:2592
    v_exp_f32 v26, v26
    v_accvgpr_read_b32 v227, a188
    v_rcp_f32 v224, v225
    v_mfma_f32_16x16x32_bf16 v[184:187], a[168:171], v[64:67], v[184:187]
    s_waitcnt lgkmcnt(0)
    s_barrier
    ds_read_b64_tr_b16 a[166:167], v5 offset:3616
    v_add_f32 v14, v14, v225
    v_rcp_f32 v226, v227
    v_mfma_f32_16x16x32_bf16 v[216:219], a[168:171], v[68:71], v[216:219]
    ds_read_b128 v[240:243], v12 offset:0
    v_exp_f32 v27, v27
    v_add_f32 v14, v14, v227
    v_mfma_f32_16x16x32_bf16 v[220:223], a[172:175], v[68:71], v[220:223]
    ds_read_b128 v[244:247], v12 offset:1024
    v_cvt_pk_bf16_f32 v61, v26, v27
    v_mfma_f32_16x16x32_bf16 v[188:191], a[172:175], v[64:67], v[188:191]
    v_exp_f32 v28, v28
    v_mfma_f32_16x16x32_bf16 v[88:91], a[200:203], a[80:83], 0
    ds_write_b64 v8, v[148:149] offset:4512
    v_sub_f32 v84, 0, v84
    v_mfma_f32_16x16x32_bf16 v[88:91], a[204:207], a[84:87], v[88:91]
    v_sub_f32 v85, 0, v85
    v_cvt_pk_bf16_f32 v120, v120, v121
    v_cvt_pk_bf16_f32 v121, v122, v123
    v_mfma_f32_16x16x32_bf16 v[88:91], a[208:211], a[88:91], v[88:91]
    ds_write_b64 v8, v[120:121] offset:192
    v_sub_f32 v86, 0, v86
    v_mfma_f32_16x16x32_bf16 v[88:91], a[212:215], a[92:95], v[88:91]
    v_sub_f32 v87, 0, v87
    v_cvt_pk_bf16_f32 v152, v152, v153
    v_cvt_pk_bf16_f32 v153, v154, v155
    s_cbranch_vccnz L_fix0b0
L_fix0b0r:
    v_mfma_f32_16x16x32_bf16 v[48:51], a[112:115], a[96:99], v[92:95]
    ds_read_b128 v[248:251], v12 offset:2048
    ds_read_b128 v[252:255], v12 offset:3072
    ds_write_b64 v8, v[152:153] offset:4544
    v_pk_mul_f32 v[160:161], v[160:161], v[224:225] op_sel_hi:[1,0]
    v_pk_mul_f32 v[162:163], v[162:163], v[224:225] op_sel_hi:[1,0]
    v_pk_mul_f32 v[192:193], v[192:193], v[226:227] op_sel_hi:[1,0]
    v_pk_mul_f32 v[194:195], v[194:195], v[226:227] op_sel_hi:[1,0]
    v_pk_mul_f32 v[164:165], v[164:165], v[224:225] op_sel_hi:[1,0]
    v_pk_mul_f32 v[166:167], v[166:167], v[224:225] op_sel_hi:[1,0]
    v_pk_mul_f32 v[196:197], v[196:197], v[226:227] op_sel_hi:[1,0]
    v_pk_mul_f32 v[198:199], v[198:199], v[226:227] op_sel_hi:[1,0]
    v_pk_mul_f32 v[168:169], v[168:169], v[224:225] op_sel_hi:[1,0]
    v_pk_mul_f32 v[170:171], v[170:171], v[224:225] op_sel_hi:[1,0]
    v_pk_mul_f32 v[200:201], v[200:201], v[226:227] op_sel_hi:[1,0]
    v_pk_mul_f32 v[202:203], v[202:203], v[226:227] op_sel_hi:[1,0]
    v_pk_mul_f32 v[172:173], v[172:173], v[224:225] op_sel_hi:[1,0]
    v_pk_mul_f32 v[174:175], v[174:175], v[224:225] op_sel_hi:[1,0]
    v_pk_mul_f32 v[204:205], v[204:205], v[226:227] op_sel_hi:[1,0]
    v_pk_mul_f32 v[206:207], v[206:207], v[226:227] op_sel_hi:[1,0]
    v_pk_mul_f32 v[176:177], v[176:177], v[224:225] op_sel_hi:[1,0]
    v_pk_mul_f32 v[178:179], v[178:179], v[224:225] op_sel_hi:[1,0]
    v_pk_mul_f32 v[208:209], v[208:209], v[226:227] op_sel_hi:[1,0]
    v_pk_mul_f32 v[210:211], v[210:211], v[226:227] op_sel_hi:[1,0]
    v_pk_mul_f32 v[180:181], v[180:181], v[224:225] op_sel_hi:[1,0]
    v_pk_mul_f32 v[182:183], v[182:183], v[224:225] op_sel_hi:[1,0]
    v_pk_mul_f32 v[212:213], v[212:213], v[226:227] op_sel_hi:[1,0]
    v_pk_mul_f32 v[214:215], v[214:215], v[226:227] op_sel_hi:[1,0]
    v_pk_mul_f32 v[184:185], v[184:185], v[224:225] op_sel_hi:[1,0]
    v_pk_mul_f32 v[186:187], v[186:187], v[224:225] op_sel_hi:[1,0]
    v_pk_mul_f32 v[216:217], v[216:217], v[226:227] op_sel_hi:[1,0]
    v_pk_mul_f32 v[218:219], v[218:219], v[226:227] op_sel_hi:[1,0]
    v_pk_mul_f32 v[188:189], v[188:189], v[224:225] op_sel_hi:[1,0]
    v_pk_mul_f32 v[190:191], v[190:191], v[224:225] op_sel_hi:[1,0]
    v_pk_mul_f32 v[220:221], v[220:221], v[226:227] op_sel_hi:[1,0]
    v_pk_mul_f32 v[222:223], v[222:223], v[226:227] op_sel_hi:[1,0]
    v_cvt_pk_bf16_f32 v124, v124, v125
    v_cvt_pk_bf16_f32 v125, v126, v127
    v_cvt_pk_bf16_f32 v160, v160, v161
    v_cvt_pk_bf16_f32 v161, v162, v163
    v_mfma_f32_16x16x32_bf16 v[48:51], a[116:119], a[100:103], v[48:51]
    ds_write_b64 v8, v[160:161] offset:8704
    v_exp_f32 v29, v29
    v_cvt_pk_bf16_f32 v192, v192, v193
    v_mfma_f32_16x16x32_bf16 v[48:51], a[120:123], a[104:107], v[48:51]
    ds_read_b32 v232, v13 offset:0
    v_cvt_pk_bf16_f32 v62, v28, v29
    v_mfma_f32_16x16x32_bf16 v[48:51], a[124:127], a[108:111], v[48:51]
    v_exp_f32 v30, v30
    v_cvt_pk_bf16_f32 v193, v194, v195
    v_mfma_f32_16x16x32_bf16 v[52:55], a[128:131], a[96:99], v[92:95]
    ds_read_b64_tr_b16 a[148:149], v5 offset:2080
    ds_read_b64_tr_b16 a[150:151], v5 offset:3104
    v_mfma_f32_16x16x32_bf16 v[52:55], a[132:135], a[100:103], v[52:55]
    v_exp_f32 v31, v31
    v_mfma_f32_16x16x32_bf16 v[52:55], a[136:139], a[104:107], v[52:55]
    ds_read_b64_tr_b16 a[152:153], v5 offset:2304
    v_cvt_pk_bf16_f32 v63, v30, v31
    v_mfma_f32_16x16x32_bf16 v[52:55], a[140:143], a[108:111], v[52:55]
    ds_read_b64_tr_b16 a[154:155], v5 offset:3328
    ds_read_b64_tr_b16 a[156:157], v5 offset:2336
    v_mfma_f32_16x16x32_bf16 v[32:35], a[112:115], a[64:67], v[84:87]
    v_exp_f32 v48, v48
    v_mfma_f32_16x16x32_bf16 v[32:35], a[116:119], a[68:71], v[32:35]
    s_waitcnt lgkmcnt(5)
    buffer_load_dwordx4 v1, s[16:19], s64 offen nt lds
    ds_write_b64 v8, v[192:193] offset:13056
    v_accvgpr_read_b32 v233, a192
    v_mfma_f32_16x16x32_bf16 v[32:35], a[120:123], a[72:75], v[32:35]
    v_exp_f32 v49, v49
    v_add_f32 v232, v232, v233
    v_rcp_f32 v234, v232
    v_mfma_f32_16x16x32_bf16 v[32:35], a[124:127], a[76:79], v[32:35]
    ds_read_b64_tr_b16 a[158:159], v5 offset:3360
    v_cvt_pk_bf16_f32 v72, v48, v49
    v_add_f32 v14, v14, v232
    v_accvgpr_read_b32 v228, a0
    v_accvgpr_read_b32 v229, a1
    v_accvgpr_read_b32 v230, a2
    v_accvgpr_read_b32 v231, a3
    v_add_f32 v240, v240, v228
    v_add_f32 v241, v241, v229
    v_cvt_pk_bf16_f32 v164, v164, v165
    v_cvt_pk_bf16_f32 v165, v166, v167
    v_mfma_f32_16x16x32_bf16 v[36:39], a[128:131], a[64:67], v[84:87]
    ds_write_b64 v8, v[164:165] offset:8736
    v_exp_f32 v50, v50
    v_add_f32 v242, v242, v230
    v_add_f32 v243, v243, v231
    v_mul_f32 v240, v240, v234
    v_mul_f32 v241, v241, v234
    v_mul_f32 v242, v242, v234
    v_mul_f32 v243, v243, v234
    v_cvt_pk_bf16_f32 v240, v240, v241
    v_cvt_pk_bf16_f32 v196, v196, v197
    v_cvt_pk_bf16_f32 v197, v198, v199
    v_mfma_f32_16x16x32_bf16 v[36:39], a[132:135], a[68:71], v[36:39]
    buffer_load_dwordx4 v1, s[16:19], s64 offen offset:1024 nt lds
    ds_write_b64 v8, v[196:197] offset:13088
    v_cvt_pk_bf16_f32 v241, v242, v243
    v_mfma_f32_16x16x32_bf16 v[36:39], a[136:139], a[72:75], v[36:39]
    ds_write_b64 v9, v[240:241] offset:0
    v_exp_f32 v51, v51
    v_accvgpr_read_b32 v228, a4
    v_accvgpr_read_b32 v229, a5
    v_accvgpr_read_b32 v230, a6
    v_accvgpr_read_b32 v231, a7
    v_add_f32 v244, v244, v228
    v_add_f32 v245, v245, v229
    v_cvt_pk_bf16_f32 v168, v168, v169
    v_cvt_pk_bf16_f32 v169, v170, v171
    v_mfma_f32_16x16x32_bf16 v[36:39], a[140:143], a[76:79], v[36:39]
    ds_read_b64_tr_b16 a[160:161], v5 offset:2560
    ds_write_b64 v8, v[168:169] offset:8768
    v_cvt_pk_bf16_f32 v73, v50, v51
    v_add_f32 v246, v246, v230
    v_add_f32 v247, v247, v231
    v_mul_f32 v244, v244, v234
    v_mul_f32 v245, v245, v234
    v_mul_f32 v246, v246, v234
    v_mul_f32 v247, v247, v234
    v_cvt_pk_bf16_f32 v244, v244, v245
    v_cvt_pk_bf16_f32 v200, v200, v201
    v_cvt_pk_bf16_f32 v201, v202, v203
    v_mfma_f32_16x16x32_bf16 a[176:179], a[196:199], v[56:59], 0
    ds_write_b64 v8, v[200:201] offset:13120
    v_exp_f32 v52, v52
    v_cvt_pk_bf16_f32 v245, v246, v247
    v_mfma_f32_16x16x32_bf16 a[180:183], a[196:199], v[60:63], 0
    buffer_load_dwordx4 v1, s[20:23], s65 offen offset:2048 nt lds
    ds_write_b64 v9, v[244:245] offset:32
    v_accvgpr_read_b32 v228, a8
    v_accvgpr_read_b32 v229, a9
    v_accvgpr_read_b32 v230, a10
    v_accvgpr_read_b32 v231, a11
    v_add_f32 v248, v248, v228
    v_add_f32 v249, v249, v229
    v_cvt_pk_bf16_f32 v172, v172, v173
    v_cvt_pk_bf16_f32 v173, v174, v175
    v_mfma_f32_16x16x32_bf16 v[96:99], a[144:147], v[56:59], 0
    ds_write_b64 v8, v[172:173] offset:8800
    v_exp_f32 v53, v53
    v_add_f32 v250, v250, v230
    v_add_f32 v251, v251, v231
    v_mul_f32 v248, v248, v234
    v_mul_f32 v249, v249, v234
    v_mul_f32 v250, v250, v234
    v_mul_f32 v251, v251, v234
    v_cvt_pk_bf16_f32 v248, v248, v249
    v_cvt_pk_bf16_f32 v204, v204, v205
    v_cvt_pk_bf16_f32 v205, v206, v207
    v_mfma_f32_16x16x32_bf16 v[128:131], a[144:147], v[60:63], 0
    s_waitcnt lgkmcnt(7)
    ds_read_b64_tr_b16 a[162:163], v5 offset:3584
    v_cvt_pk_bf16_f32 v74, v52, v53
    v_mfma_f32_16x16x32_bf16 v[132:135], a[148:151], v[60:63], 0
    ds_write_b64 v8, v[204:205] offset:13152
    v_exp_f32 v54, v54
    v_cvt_pk_bf16_f32 v249, v250, v251
    v_mfma_f32_16x16x32_bf16 v[100:103], a[148:151], v[56:59], 0
    buffer_load_dwordx4 v1, s[20:23], s65 offen offset:3072 nt lds
    ds_write_b64 v9, v[248:249] offset:64
    v_accvgpr_read_b32 v228, a12
    v_mfma_f32_16x16x32_bf16 v[104:107], a[152:155], v[56:59], 0
    s_mov_b32 s65, s64
    v_exp_f32 v55, v55
    v_mfma_f32_16x16x32_bf16 v[136:139], a[152:155], v[60:63], 0
    s_add_u32 s31, s31, 8192
    ds_read_b64_tr_b16 a[168:169], v5 offset:2816
    v_cvt_pk_bf16_f32 v75, v54, v55
    v_mfma_f32_16x16x32_bf16 v[140:143], a[156:159], v[60:63], 0
    s_or_b32 s31, s31, s67
    ds_read_b64_tr_b16 a[170:171], v5 offset:3840
    ds_read_b64_tr_b16 a[172:173], v5 offset:2848
    v_mfma_f32_16x16x32_bf16 v[108:111], a[156:159], v[56:59], 0
    s_waitcnt lgkmcnt(5)
    s_xor_b32 s64, s31, s66
    v_exp_f32 v32, v32
    v_mfma_f32_16x16x32_bf16 v[112:115], a[160:163], v[56:59], 0
    s_add_u32 m0, s30, s32
    ds_read_b64_tr_b16 a[174:175], v5 offset:3872
    v_sub_f32 v88, 0, v88
    v_mfma_f32_16x16x32_bf16 v[144:147], a[160:163], v[60:63], 0
    s_add_u32 s30, s30, 16512
    v_exp_f32 v33, v33
    v_mfma_f32_16x16x32_bf16 v[148:151], a[164:167], v[60:63], 0
    s_cmp_eq_u32 s30, 82560
    ds_write_b64 v8, v[124:125] offset:224
    v_cvt_pk_bf16_f32 v64, v32, v33
    v_sub_f32 v89, 0, v89
    v_cvt_pk_bf16_f32 v156, v156, v157
    v_cvt_pk_bf16_f32 v157, v158, v159
    v_accvgpr_read_b32 v229, a13
    v_accvgpr_read_b32 v230, a14
    v_accvgpr_read_b32 v231, a15
    v_add_f32 v252, v252, v228
    v_add_f32 v253, v253, v229
    v_add_f32 v254, v254, v230
    v_add_f32 v255, v255, v231
    v_cvt_pk_bf16_f32 v176, v176, v177
    v_cvt_pk_bf16_f32 v177, v178, v179
    v_mfma_f32_16x16x32_bf16 v[116:119], a[164:167], v[56:59], 0
    s_waitcnt lgkmcnt(3)
    s_cselect_b32 s30, 0, s30
    v_exp_f32 v34, v34
    v_mfma_f32_16x16x32_bf16 v[120:123], a[168:171], v[56:59], 0
    ds_write_b64 v8, v[156:157] offset:4576
    ds_write_b64 v8, v[176:177] offset:8832
    v_sub_f32 v90, 0, v90
    v_sub_f32 v91, 0, v91
    v_mul_f32 v252, v252, v234
    v_mul_f32 v253, v253, v234
    v_mul_f32 v254, v254, v234
    v_mul_f32 v255, v255, v234
    v_cvt_pk_bf16_f32 v252, v252, v253
    s_branch L_pg6
    .p2align 12
L_pa6:
    s_branch L_wa
L_pb6:
    s_branch L_wb1
L_pg6:
    v_cvt_pk_bf16_f32 v253, v254, v255
    v_cvt_pk_bf16_f32 v208, v208, v209
    v_cvt_pk_bf16_f32 v209, v210, v211
    s_cbranch_vccnz L_fix0b1
L_fix0b1r:
    v_mfma_f32_16x16x32_bf16 v[152:155], a[168:171], v[60:63], 0
    s_waitcnt lgkmcnt(3)
    v_exp_f32 v35, v35
    v_mfma_f32_16x16x32_bf16 v[156:159], a[172:175], v[60:63], 0
    ds_write_b64 v9, v[252:253] offset:96
    ds_write_b64 v8, v[208:209] offset:13184
    v_cvt_pk_bf16_f32 v65, v34, v35
    v_mfma_f32_16x16x32_bf16 v[124:127], a[172:175], v[56:59], 0
    v_exp_f32 v36, v36
    v_mfma_f32_16x16x32_bf16 v[40:43], a[112:115], a[80:83], v[88:91]
    ds_read_b128 a[112:115], v4 offset:0
    v_add_u32 v5, s30, v3
    v_mfma_f32_16x16x32_bf16 v[40:43], a[116:119], a[84:87], v[40:43]
    v_exp_f32 v37, v37
    v_mfma_f32_16x16x32_bf16 v[40:43], a[120:123], a[88:91], v[40:43]
    ds_read_b128 a[116:119], v4 offset:256
    v_cvt_pk_bf16_f32 v66, v36, v37
    v_mfma_f32_16x16x32_bf16 v[40:43], a[124:127], a[92:95], v[40:43]
    v_exp_f32 v38, v38
    v_mfma_f32_16x16x32_bf16 v[44:47], a[128:131], a[80:83], v[88:91]
    ds_read_b128 a[120:123], v4 offset:512
    ds_read_b128 a[124:127], v4 offset:768
    v_mfma_f32_16x16x32_bf16 v[44:47], a[132:135], a[84:87], v[44:47]
    v_exp_f32 v39, v39
    v_mfma_f32_16x16x32_bf16 v[44:47], a[136:139], a[88:91], v[44:47]
    ds_read_b128 a[128:131], v4 offset:1024
    v_cvt_pk_bf16_f32 v67, v38, v39
    v_mfma_f32_16x16x32_bf16 v[44:47], a[140:143], a[92:95], v[44:47]
    ds_read_b128 a[132:135], v4 offset:1280
    ds_read_b128 a[136:139], v4 offset:1536
    v_mfma_f32_16x16x32_bf16 a[192:195], a[196:199], v[72:75], 0
    v_exp_f32 v40, v40
    v_mfma_f32_16x16x32_bf16 a[0:3], a[144:147], v[72:75], 0
    ds_read_b128 a[140:143], v4 offset:1792
    v_add_u32 v4, s30, v2
    v_mfma_f32_16x16x32_bf16 a[4:7], a[148:151], v[72:75], 0
    v_exp_f32 v41, v41
    v_mfma_f32_16x16x32_bf16 a[8:11], a[152:155], v[72:75], 0
    v_cvt_pk_bf16_f32 v68, v40, v41
    v_cvt_pk_bf16_f32 v180, v180, v181
    v_cvt_pk_bf16_f32 v181, v182, v183
    v_mfma_f32_16x16x32_bf16 a[12:15], a[156:159], v[72:75], 0
    v_exp_f32 v42, v42
    v_mfma_f32_16x16x32_bf16 a[16:19], a[160:163], v[72:75], 0
    ds_write_b64 v8, v[180:181] offset:8864
    v_mfma_f32_16x16x32_bf16 a[20:23], a[164:167], v[72:75], 0
    v_exp_f32 v43, v43
    v_mfma_f32_16x16x32_bf16 a[24:27], a[168:171], v[72:75], 0
    v_cvt_pk_bf16_f32 v69, v42, v43
    v_cvt_pk_bf16_f32 v212, v212, v213
    v_cvt_pk_bf16_f32 v213, v214, v215
    v_mfma_f32_16x16x32_bf16 a[28:31], a[172:175], v[72:75], 0
    s_waitcnt lgkmcnt(1)
    v_exp_f32 v44, v44
    v_mfma_f32_16x16x32_bf16 v[16:19], a[112:115], a[32:35], v[76:79]
    ds_write_b64 v8, v[212:213] offset:13216
    v_mfma_f32_16x16x32_bf16 v[16:19], a[116:119], a[36:39], v[16:19]
    v_exp_f32 v45, v45
    v_mfma_f32_16x16x32_bf16 v[16:19], a[120:123], a[40:43], v[16:19]
    v_cvt_pk_bf16_f32 v70, v44, v45
    v_cvt_pk_bf16_f32 v184, v184, v185
    v_cvt_pk_bf16_f32 v185, v186, v187
    v_mfma_f32_16x16x32_bf16 v[16:19], a[124:127], a[44:47], v[16:19]
    v_exp_f32 v46, v46
    v_mfma_f32_16x16x32_bf16 v[20:23], a[128:131], a[32:35], v[76:79]
    ds_write_b64 v8, v[184:185] offset:8896
    v_mfma_f32_16x16x32_bf16 v[20:23], a[132:135], a[36:39], v[20:23]
    v_exp_f32 v47, v47
    v_mfma_f32_16x16x32_bf16 v[20:23], a[136:139], a[40:43], v[20:23]
    v_cvt_pk_bf16_f32 v71, v46, v47
    v_cvt_pk_bf16_f32 v216, v216, v217
    v_cvt_pk_bf16_f32 v217, v218, v219
    v_mfma_f32_16x16x32_bf16 v[20:23], a[140:143], a[44:47], v[20:23]
    ds_write_b64 v8, v[216:217] offset:13248
    v_cvt_pk_bf16_f32 v188, v188, v189
    v_mfma_f32_16x16x32_bf16 v[24:27], a[112:115], a[48:51], v[80:83]
    v_exp_f32 v16, v16
    v_cvt_pk_bf16_f32 v189, v190, v191
    v_mfma_f32_16x16x32_bf16 v[24:27], a[116:119], a[52:55], v[24:27]
    s_waitcnt vmcnt(16) lgkmcnt(0)
    s_barrier
    v_mfma_f32_16x16x32_bf16 v[24:27], a[120:123], a[56:59], v[24:27]
    v_exp_f32 v17, v17
    v_mfma_f32_16x16x32_bf16 v[24:27], a[124:127], a[60:63], v[24:27]
    ds_write_b64 v8, v[188:189] offset:8928
    v_cvt_pk_bf16_f32 v56, v16, v17
    v_mfma_f32_16x16x32_bf16 v[28:31], a[128:131], a[48:51], v[80:83]
    v_exp_f32 v18, v18
    v_cvt_pk_bf16_f32 v220, v220, v221
    v_mfma_f32_16x16x32_bf16 v[28:31], a[132:135], a[52:55], v[28:31]
    buffer_load_dwordx4 v1, s[16:19], s64 offen nt lds
    v_cvt_pk_bf16_f32 v221, v222, v223
    v_mfma_f32_16x16x32_bf16 v[28:31], a[136:139], a[56:59], v[28:31]
    v_exp_f32 v19, v19
    v_mfma_f32_16x16x32_bf16 v[28:31], a[140:143], a[60:63], v[28:31]
    ds_write_b64 v8, v[220:221] offset:13280
    v_cvt_pk_bf16_f32 v57, v18, v19
    v_mfma_f32_16x16x32_bf16 a[184:187], a[196:199], v[64:67], 0
    v_exp_f32 v20, v20
    v_mfma_f32_16x16x32_bf16 a[188:191], a[196:199], v[68:71], 0
    buffer_load_dwordx4 v1, s[16:19], s64 offen offset:1024 nt lds
    v_mfma_f32_16x16x32_bf16 v[160:163], a[144:147], v[64:67], 0
    v_exp_f32 v21, v21
    v_mfma_f32_16x16x32_bf16 v[192:195], a[144:147], v[68:71], 0
    ds_read_b64_tr_b16 a[144:145], v5 offset:2048
    v_cvt_pk_bf16_f32 v58, v20, v21
    v_mfma_f32_16x16x32_bf16 v[196:199], a[148:151], v[68:71], 0
    v_exp_f32 v22, v22
    v_mfma_f32_16x16x32_bf16 v[164:167], a[148:151], v[64:67], 0
    buffer_load_dwordx4 v1, s[20:23], s65 offen offset:2048 nt lds
    v_mfma_f32_16x16x32_bf16 v[168:171], a[152:155], v[64:67], 0
    v_exp_f32 v23, v23
    v_mfma_f32_16x16x32_bf16 v[200:203], a[152:155], v[68:71], 0
    ds_read_b64_tr_b16 a[146:147], v5 offset:3072
    v_cvt_pk_bf16_f32 v59, v22, v23
    v_mfma_f32_16x16x32_bf16 v[204:207], a[156:159], v[68:71], 0
    buffer_load_dwordx4 v1, s[20:23], s65 offen offset:3072 nt lds
    v_mfma_f32_16x16x32_bf16 v[172:175], a[156:159], v[64:67], 0
    s_mov_b32 s65, s64
    v_exp_f32 v24, v24
    v_mfma_f32_16x16x32_bf16 v[176:179], a[160:163], v[64:67], 0
    s_add_u32 s31, s31, 8192
    ds_read_b64_tr_b16 a[148:149], v5 offset:2080
    ds_read_b64_tr_b16 a[150:151], v5 offset:3104
    v_mfma_f32_16x16x32_bf16 v[208:211], a[160:163], v[68:71], 0
    s_or_b32 s31, s31, s67
    v_exp_f32 v25, v25
    v_mfma_f32_16x16x32_bf16 v[212:215], a[164:167], v[68:71], 0
    s_xor_b32 s64, s31, s66
    ds_read_b64_tr_b16 a[152:153], v5 offset:2304
    v_cvt_pk_bf16_f32 v60, v24, v25
    v_mfma_f32_16x16x32_bf16 v[180:183], a[164:167], v[64:67], 0
    s_add_u32 m0, s30, s32
    v_exp_f32 v26, v26
    v_mfma_f32_16x16x32_bf16 v[184:187], a[168:171], v[64:67], 0
    s_add_u32 s30, s30, 16512
    ds_read_b64_tr_b16 a[154:155], v5 offset:3328
    ds_read_b64_tr_b16 a[156:157], v5 offset:2336
    v_mfma_f32_16x16x32_bf16 v[216:219], a[168:171], v[68:71], 0
    s_cmp_eq_u32 s30, 82560
    v_exp_f32 v27, v27
    v_mfma_f32_16x16x32_bf16 v[220:223], a[172:175], v[68:71], 0
    s_cselect_b32 s30, 0, s30
    ds_read_b64_tr_b16 a[158:159], v5 offset:3360
    v_cvt_pk_bf16_f32 v61, v26, v27
    v_mfma_f32_16x16x32_bf16 v[188:191], a[172:175], v[64:67], 0
    v_exp_f32 v28, v28
    v_mfma_f32_16x16x32_bf16 v[32:35], a[112:115], a[64:67], v[84:87]
    ds_read_b64_tr_b16 a[160:161], v5 offset:2560
    ds_read_b64_tr_b16 a[162:163], v5 offset:3584
    v_mfma_f32_16x16x32_bf16 v[32:35], a[116:119], a[68:71], v[32:35]
    v_exp_f32 v29, v29
    v_mfma_f32_16x16x32_bf16 v[32:35], a[120:123], a[72:75], v[32:35]
    ds_read_b64_tr_b16 a[164:165], v5 offset:2592
    v_cvt_pk_bf16_f32 v62, v28, v29
    v_mfma_f32_16x16x32_bf16 v[32:35], a[124:127], a[76:79], v[32:35]
    v_exp_f32 v30, v30
    v_mfma_f32_16x16x32_bf16 v[36:39], a[128:131], a[64:67], v[84:87]
    ds_read_b64_tr_b16 a[166:167], v5 offset:3616
    ds_read_b64_tr_b16 a[168:169], v5 offset:2816
    v_mfma_f32_16x16x32_bf16 v[36:39], a[132:135], a[68:71], v[36:39]
    v_exp_f32 v31, v31
    v_mfma_f32_16x16x32_bf16 v[36:39], a[136:139], a[72:75], v[36:39]
    ds_read_b64_tr_b16 a[170:171], v5 offset:3840
    v_cvt_pk_bf16_f32 v63, v30, v31
    v_mfma_f32_16x16x32_bf16 v[36:39], a[140:143], a[76:79], v[36:39]
    ds_read_b64_tr_b16 a[172:173], v5 offset:2848
    ds_read_b64_tr_b16 a[174:175], v5 offset:3872
    v_mfma_f32_16x16x32_bf16 v[40:43], a[112:115], a[80:83], v[88:91]
    v_exp_f32 v32, v32
    v_mfma_f32_16x16x32_bf16 v[40:43], a[116:119], a[84:87], v[40:43]
    ds_read_b128 a[112:115], v4 offset:0
    ds_read_b128 a[116:119], v4 offset:256
    v_mfma_f32_16x16x32_bf16 v[40:43], a[120:123], a[88:91], v[40:43]
    v_exp_f32 v33, v33
    v_mfma_f32_16x16x32_bf16 v[40:43], a[124:127], a[92:95], v[40:43]
    ds_read_b128 a[120:123], v4 offset:512
    v_cvt_pk_bf16_f32 v64, v32, v33
    v_mfma_f32_16x16x32_bf16 v[44:47], a[128:131], a[80:83], v[88:91]
    v_exp_f32 v34, v34
    v_mfma_f32_16x16x32_bf16 v[44:47], a[132:135], a[84:87], v[44:47]
    ds_read_b128 a[124:127], v4 offset:768
    ds_read_b128 a[128:131], v4 offset:1024
    v_mfma_f32_16x16x32_bf16 v[44:47], a[136:139], a[88:91], v[44:47]
    v_exp_f32 v35, v35
    v_mfma_f32_16x16x32_bf16 v[44:47], a[140:143], a[92:95], v[44:47]
    ds_read_b128 a[132:135], v4 offset:1280
    v_cvt_pk_bf16_f32 v65, v34, v35
    v_mfma_f32_16x16x32_bf16 a[176:179], a[196:199], v[56:59], a[176:179]
    v_exp_f32 v36, v36
    v_mfma_f32_16x16x32_bf16 a[180:183], a[196:199], v[60:63], a[180:183]
    s_waitcnt lgkmcnt(4)
    ds_read_b128 a[136:139], v4 offset:1536
    ds_read_b128 a[140:143], v4 offset:1792
    v_mfma_f32_16x16x32_bf16 v[96:99], a[144:147], v[56:59], v[96:99]
    v_exp_f32 v37, v37
    v_mfma_f32_16x16x32_bf16 v[128:131], a[144:147], v[60:63], v[128:131]
    v_cvt_pk_bf16_f32 v66, v36, v37
    v_mfma_f32_16x16x32_bf16 v[132:135], a[148:151], v[60:63], v[132:135]
    v_exp_f32 v38, v38
    v_mfma_f32_16x16x32_bf16 v[100:103], a[148:151], v[56:59], v[100:103]
    v_add_u32 v5, s30, v3
    v_mfma_f32_16x16x32_bf16 v[104:107], a[152:155], v[56:59], v[104:107]
    v_exp_f32 v39, v39
    v_mfma_f32_16x16x32_bf16 v[136:139], a[152:155], v[60:63], v[136:139]
    v_cvt_pk_bf16_f32 v67, v38, v39
    v_mfma_f32_16x16x32_bf16 v[140:143], a[156:159], v[60:63], v[140:143]
    v_add_u32 v4, s30, v2
    v_mfma_f32_16x16x32_bf16 v[108:111], a[156:159], v[56:59], v[108:111]
    v_exp_f32 v40, v40
    v_mfma_f32_16x16x32_bf16 v[112:115], a[160:163], v[56:59], v[112:115]
    v_mfma_f32_16x16x32_bf16 v[144:147], a[160:163], v[60:63], v[144:147]
    v_exp_f32 v41, v41
    v_mfma_f32_16x16x32_bf16 v[148:151], a[164:167], v[60:63], v[148:151]
    v_cvt_pk_bf16_f32 v68, v40, v41
    v_mfma_f32_16x16x32_bf16 v[116:119], a[164:167], v[56:59], v[116:119]
    v_exp_f32 v42, v42
    v_mfma_f32_16x16x32_bf16 v[120:123], a[168:171], v[56:59], v[120:123]
    v_mfma_f32_16x16x32_bf16 v[152:155], a[168:171], v[60:63], v[152:155]
    v_exp_f32 v43, v43
    v_mfma_f32_16x16x32_bf16 v[156:159], a[172:175], v[60:63], v[156:159]
    v_cvt_pk_bf16_f32 v69, v42, v43
    v_mfma_f32_16x16x32_bf16 v[124:127], a[172:175], v[56:59], v[124:127]
    v_exp_f32 v44, v44
    v_mfma_f32_16x16x32_bf16 v[16:19], a[112:115], a[32:35], v[76:79]
    v_mfma_f32_16x16x32_bf16 v[16:19], a[116:119], a[36:39], v[16:19]
    s_waitcnt lgkmcnt(0)
    v_exp_f32 v45, v45
    v_mfma_f32_16x16x32_bf16 v[16:19], a[120:123], a[40:43], v[16:19]
    v_cvt_pk_bf16_f32 v70, v44, v45
    v_mfma_f32_16x16x32_bf16 v[16:19], a[124:127], a[44:47], v[16:19]
    v_exp_f32 v46, v46
    v_mfma_f32_16x16x32_bf16 v[20:23], a[128:131], a[32:35], v[76:79]
    v_mfma_f32_16x16x32_bf16 v[20:23], a[132:135], a[36:39], v[20:23]
    v_exp_f32 v47, v47
    v_mfma_f32_16x16x32_bf16 v[20:23], a[136:139], a[40:43], v[20:23]
    v_cvt_pk_bf16_f32 v71, v46, v47
    v_mfma_f32_16x16x32_bf16 v[20:23], a[140:143], a[44:47], v[20:23]
    s_branch L_B0
    .p2align 12
L_pa7:
    s_branch L_wa
L_pb7:
    s_branch L_wb1
L_pg7:
L_B0:
    v_mfma_f32_16x16x32_bf16 v[24:27], a[112:115], a[48:51], v[80:83]
    v_exp_f32 v16, v16
    v_mfma_f32_16x16x32_bf16 v[24:27], a[116:119], a[52:55], v[24:27]
    v_mfma_f32_16x16x32_bf16 v[24:27], a[120:123], a[56:59], v[24:27]
    v_exp_f32 v17, v17
    v_mfma_f32_16x16x32_bf16 v[24:27], a[124:127], a[60:63], v[24:27]
    v_cvt_pk_bf16_f32 v56, v16, v17
    v_mfma_f32_16x16x32_bf16 v[28:31], a[128:131], a[48:51], v[80:83]
    v_exp_f32 v18, v18
    v_mfma_f32_16x16x32_bf16 v[28:31], a[132:135], a[52:55], v[28:31]
    v_mfma_f32_16x16x32_bf16 v[28:31], a[136:139], a[56:59], v[28:31]
    v_exp_f32 v19, v19
    v_mfma_f32_16x16x32_bf16 v[28:31], a[140:143], a[60:63], v[28:31]
    v_cvt_pk_bf16_f32 v57, v18, v19
    v_mfma_f32_16x16x32_bf16 a[184:187], a[196:199], v[64:67], a[184:187]
    v_exp_f32 v20, v20
    v_mfma_f32_16x16x32_bf16 a[188:191], a[196:199], v[68:71], a[188:191]
    s_waitcnt vmcnt(12)
    s_barrier
    v_mfma_f32_16x16x32_bf16 v[160:163], a[144:147], v[64:67], v[160:163]
    v_exp_f32 v21, v21
    v_mfma_f32_16x16x32_bf16 v[192:195], a[144:147], v[68:71], v[192:195]
    ds_read_b64_tr_b16 a[144:145], v5 offset:2048
    v_cvt_pk_bf16_f32 v58, v20, v21
    v_mfma_f32_16x16x32_bf16 v[196:199], a[148:151], v[68:71], v[196:199]
    v_exp_f32 v22, v22
    v_mfma_f32_16x16x32_bf16 v[164:167], a[148:151], v[64:67], v[164:167]
    buffer_load_dwordx4 v1, s[16:19], s64 offen nt lds
    v_mfma_f32_16x16x32_bf16 v[168:171], a[152:155], v[64:67], v[168:171]
    v_exp_f32 v23, v23
    v_mfma_f32_16x16x32_bf16 v[200:203], a[152:155], v[68:71], v[200:203]
    ds_read_b64_tr_b16 a[146:147], v5 offset:3072
    v_cvt_pk_bf16_f32 v59, v22, v23
    v_mfma_f32_16x16x32_bf16 v[204:207], a[156:159], v[68:71], v[204:207]
    buffer_load_dwordx4 v1, s[16:19], s64 offen offset:1024 nt lds
    v_mfma_f32_16x16x32_bf16 v[172:175], a[156:159], v[64:67], v[172:175]
    v_exp_f32 v24, v24
    v_mfma_f32_16x16x32_bf16 v[176:179], a[160:163], v[64:67], v[176:179]
    buffer_load_dwordx4 v1, s[20:23], s65 offen offset:2048 nt lds
    v_mfma_f32_16x16x32_bf16 v[208:211], a[160:163], v[68:71], v[208:211]
    v_exp_f32 v25, v25
    v_mfma_f32_16x16x32_bf16 v[212:215], a[164:167], v[68:71], v[212:215]
    ds_read_b64_tr_b16 a[148:149], v5 offset:2080
    v_cvt_pk_bf16_f32 v60, v24, v25
    v_mfma_f32_16x16x32_bf16 v[180:183], a[164:167], v[64:67], v[180:183]
    v_exp_f32 v26, v26
    v_mfma_f32_16x16x32_bf16 v[184:187], a[168:171], v[64:67], v[184:187]
    buffer_load_dwordx4 v1, s[20:23], s65 offen offset:3072 nt lds
    v_mfma_f32_16x16x32_bf16 v[216:219], a[168:171], v[68:71], v[216:219]
    s_mov_b32 s65, s64
    v_exp_f32 v27, v27
    v_mfma_f32_16x16x32_bf16 v[220:223], a[172:175], v[68:71], v[220:223]
    s_add_u32 s31, s31, 8192
    ds_read_b64_tr_b16 a[150:151], v5 offset:3104
    v_cvt_pk_bf16_f32 v61, v26, v27
    v_mfma_f32_16x16x32_bf16 v[188:191], a[172:175], v[64:67], v[188:191]
    s_or_b32 s31, s31, s67
    v_exp_f32 v28, v28
    v_mfma_f32_16x16x32_bf16 v[48:51], a[112:115], a[96:99], v[92:95]
    s_xor_b32 s64, s31, s66
    ds_read_b64_tr_b16 a[152:153], v5 offset:2304
    ds_read_b64_tr_b16 a[154:155], v5 offset:3328
    v_mfma_f32_16x16x32_bf16 v[48:51], a[116:119], a[100:103], v[48:51]
    s_add_u32 m0, s30, s32
    v_exp_f32 v29, v29
    v_mfma_f32_16x16x32_bf16 v[48:51], a[120:123], a[104:107], v[48:51]
    s_add_u32 s30, s30, 16512
    ds_read_b64_tr_b16 a[156:157], v5 offset:2336
    v_cvt_pk_bf16_f32 v62, v28, v29
    v_mfma_f32_16x16x32_bf16 v[48:51], a[124:127], a[108:111], v[48:51]
    s_cmp_eq_u32 s30, 82560
    v_exp_f32 v30, v30
    v_mfma_f32_16x16x32_bf16 v[52:55], a[128:131], a[96:99], v[92:95]
    s_cselect_b32 s30, 0, s30
    ds_read_b64_tr_b16 a[158:159], v5 offset:3360
    ds_read_b64_tr_b16 a[160:161], v5 offset:2560
    v_mfma_f32_16x16x32_bf16 v[52:55], a[132:135], a[100:103], v[52:55]
    v_exp_f32 v31, v31
    v_mfma_f32_16x16x32_bf16 v[52:55], a[136:139], a[104:107], v[52:55]
    ds_read_b64_tr_b16 a[162:163], v5 offset:3584
    v_cvt_pk_bf16_f32 v63, v30, v31
    v_mfma_f32_16x16x32_bf16 v[52:55], a[140:143], a[108:111], v[52:55]
    ds_read_b64_tr_b16 a[164:165], v5 offset:2592
    ds_read_b64_tr_b16 a[166:167], v5 offset:3616
    v_mfma_f32_16x16x32_bf16 v[32:35], a[112:115], a[64:67], v[84:87]
    v_exp_f32 v48, v48
    v_mfma_f32_16x16x32_bf16 v[32:35], a[116:119], a[68:71], v[32:35]
    ds_read_b64_tr_b16 a[168:169], v5 offset:2816
    ds_read_b64_tr_b16 a[170:171], v5 offset:3840
    v_mfma_f32_16x16x32_bf16 v[32:35], a[120:123], a[72:75], v[32:35]
    v_exp_f32 v49, v49
    v_mfma_f32_16x16x32_bf16 v[32:35], a[124:127], a[76:79], v[32:35]
    ds_read_b64_tr_b16 a[172:173], v5 offset:2848
    v_cvt_pk_bf16_f32 v72, v48, v49
    v_mfma_f32_16x16x32_bf16 v[36:39], a[128:131], a[64:67], v[84:87]
    v_exp_f32 v50, v50
    v_mfma_f32_16x16x32_bf16 v[36:39], a[132:135], a[68:71], v[36:39]
    ds_read_b64_tr_b16 a[174:175], v5 offset:3872
    v_add_u32 v5, s30, v3
    v_mfma_f32_16x16x32_bf16 v[36:39], a[136:139], a[72:75], v[36:39]
    v_exp_f32 v51, v51
    v_mfma_f32_16x16x32_bf16 v[36:39], a[140:143], a[76:79], v[36:39]
    v_cvt_pk_bf16_f32 v73, v50, v51
    v_mfma_f32_16x16x32_bf16 a[176:179], a[196:199], v[56:59], a[176:179]
    v_exp_f32 v52, v52
    v_mfma_f32_16x16x32_bf16 a[180:183], a[196:199], v[60:63], a[180:183]
    s_waitcnt lgkmcnt(2)
    v_mfma_f32_16x16x32_bf16 v[96:99], a[144:147], v[56:59], v[96:99]
    v_exp_f32 v53, v53
    v_mfma_f32_16x16x32_bf16 v[128:131], a[144:147], v[60:63], v[128:131]
    v_cvt_pk_bf16_f32 v74, v52, v53
    v_mfma_f32_16x16x32_bf16 v[132:135], a[148:151], v[60:63], v[132:135]
    v_exp_f32 v54, v54
    v_mfma_f32_16x16x32_bf16 v[100:103], a[148:151], v[56:59], v[100:103]
    v_mfma_f32_16x16x32_bf16 v[104:107], a[152:155], v[56:59], v[104:107]
    v_exp_f32 v55, v55
    v_mfma_f32_16x16x32_bf16 v[136:139], a[152:155], v[60:63], v[136:139]
    v_cvt_pk_bf16_f32 v75, v54, v55
    v_mfma_f32_16x16x32_bf16 v[140:143], a[156:159], v[60:63], v[140:143]
    v_mfma_f32_16x16x32_bf16 v[108:111], a[156:159], v[56:59], v[108:111]
    v_exp_f32 v32, v32
    v_mfma_f32_16x16x32_bf16 v[112:115], a[160:163], v[56:59], v[112:115]
    v_mfma_f32_16x16x32_bf16 v[144:147], a[160:163], v[60:63], v[144:147]
    v_exp_f32 v33, v33
    v_mfma_f32_16x16x32_bf16 v[148:151], a[164:167], v[60:63], v[148:151]
    v_cvt_pk_bf16_f32 v64, v32, v33
    v_mfma_f32_16x16x32_bf16 v[116:119], a[164:167], v[56:59], v[116:119]
    v_exp_f32 v34, v34
    v_mfma_f32_16x16x32_bf16 v[120:123], a[168:171], v[56:59], v[120:123]
    v_mfma_f32_16x16x32_bf16 v[152:155], a[168:171], v[60:63], v[152:155]
    s_waitcnt lgkmcnt(0)
    v_exp_f32 v35, v35
    v_mfma_f32_16x16x32_bf16 v[156:159], a[172:175], v[60:63], v[156:159]
    v_cvt_pk_bf16_f32 v65, v34, v35
    v_mfma_f32_16x16x32_bf16 v[124:127], a[172:175], v[56:59], v[124:127]
    v_exp_f32 v36, v36
    v_mfma_f32_16x16x32_bf16 v[40:43], a[112:115], a[80:83], v[88:91]
    ds_read_b128 a[112:115], v4 offset:0
    v_mfma_f32_16x16x32_bf16 v[40:43], a[116:119], a[84:87], v[40:43]
    v_exp_f32 v37, v37
    v_mfma_f32_16x16x32_bf16 v[40:43], a[120:123], a[88:91], v[40:43]
    ds_read_b128 a[116:119], v4 offset:256
    v_cvt_pk_bf16_f32 v66, v36, v37
    v_mfma_f32_16x16x32_bf16 v[40:43], a[124:127], a[92:95], v[40:43]
    v_exp_f32 v38, v38
    v_mfma_f32_16x16x32_bf16 v[44:47], a[128:131], a[80:83], v[88:91]
    ds_read_b128 a[120:123], v4 offset:512
    ds_read_b128 a[124:127], v4 offset:768
    v_mfma_f32_16x16x32_bf16 v[44:47], a[132:135], a[84:87], v[44:47]
    v_exp_f32 v39, v39
    v_mfma_f32_16x16x32_bf16 v[44:47], a[136:139], a[88:91], v[44:47]
    ds_read_b128 a[128:131], v4 offset:1024
    v_cvt_pk_bf16_f32 v67, v38, v39
    v_mfma_f32_16x16x32_bf16 v[44:47], a[140:143], a[92:95], v[44:47]
    ds_read_b128 a[132:135], v4 offset:1280
    ds_read_b128 a[136:139], v4 offset:1536
    v_mfma_f32_16x16x32_bf16 a[192:195], a[196:199], v[72:75], a[192:195]
    v_exp_f32 v40, v40
    v_mfma_f32_16x16x32_bf16 a[0:3], a[144:147], v[72:75], a[0:3]
    ds_read_b128 a[140:143], v4 offset:1792
    v_add_u32 v4, s30, v2
    v_mfma_f32_16x16x32_bf16 a[4:7], a[148:151], v[72:75], a[4:7]
    v_exp_f32 v41, v41
    v_mfma_f32_16x16x32_bf16 a[8:11], a[152:155], v[72:75], a[8:11]
    v_cvt_pk_bf16_f32 v68, v40, v41
    v_mfma_f32_16x16x32_bf16 a[12:15], a[156:159], v[72:75], a[12:15]
    v_exp_f32 v42, v42
    v_mfma_f32_16x16x32_bf16 a[16:19], a[160:163], v[72:75], a[16:19]
    v_mfma_f32_16x16x32_bf16 a[20:23], a[164:167], v[72:75], a[20:23]
    v_exp_f32 v43, v43
    v_mfma_f32_16x16x32_bf16 a[24:27], a[168:171], v[72:75], a[24:27]
    v_cvt_pk_bf16_f32 v69, v42, v43
    v_mfma_f32_16x16x32_bf16 a[28:31], a[172:175], v[72:75], a[28:31]
    s_waitcnt lgkmcnt(0)
    v_exp_f32 v44, v44
    v_mfma_f32_16x16x32_bf16 v[16:19], a[112:115], a[32:35], v[76:79]
    v_mfma_f32_16x16x32_bf16 v[16:19], a[116:119], a[36:39], v[16:19]
    v_exp_f32 v45, v45
    v_mfma_f32_16x16x32_bf16 v[16:19], a[120:123], a[40:43], v[16:19]
    v_cvt_pk_bf16_f32 v70, v44, v45
    v_mfma_f32_16x16x32_bf16 v[16:19], a[124:127], a[44:47], v[16:19]
    v_exp_f32 v46, v46
    v_mfma_f32_16x16x32_bf16 v[20:23], a[128:131], a[32:35], v[76:79]
    v_mfma_f32_16x16x32_bf16 v[20:23], a[132:135], a[36:39], v[20:23]
    v_exp_f32 v47, v47
    v_mfma_f32_16x16x32_bf16 v[20:23], a[136:139], a[40:43], v[20:23]
    v_cvt_pk_bf16_f32 v71, v46, v47
    v_mfma_f32_16x16x32_bf16 v[20:23], a[140:143], a[44:47], v[20:23]
    v_mfma_f32_16x16x32_bf16 v[24:27], a[112:115], a[48:51], v[80:83]
    v_exp_f32 v16, v16
    v_mfma_f32_16x16x32_bf16 v[24:27], a[116:119], a[52:55], v[24:27]
    s_waitcnt vmcnt(12)
    s_barrier
    v_mfma_f32_16x16x32_bf16 v[24:27], a[120:123], a[56:59], v[24:27]
    v_exp_f32 v17, v17
    v_mfma_f32_16x16x32_bf16 v[24:27], a[124:127], a[60:63], v[24:27]
    v_cvt_pk_bf16_f32 v56, v16, v17
    v_mfma_f32_16x16x32_bf16 v[28:31], a[128:131], a[48:51], v[80:83]
    v_exp_f32 v18, v18
    v_mfma_f32_16x16x32_bf16 v[28:31], a[132:135], a[52:55], v[28:31]
    buffer_load_dwordx4 v1, s[16:19], s64 offen nt lds
    v_mfma_f32_16x16x32_bf16 v[28:31], a[136:139], a[56:59], v[28:31]
    v_exp_f32 v19, v19
    v_mfma_f32_16x16x32_bf16 v[28:31], a[140:143], a[60:63], v[28:31]
    v_cvt_pk_bf16_f32 v57, v18, v19
    v_mfma_f32_16x16x32_bf16 a[184:187], a[196:199], v[64:67], a[184:187]
    v_exp_f32 v20, v20
    v_mfma_f32_16x16x32_bf16 a[188:191], a[196:199], v[68:71], a[188:191]
    buffer_load_dwordx4 v1, s[16:19], s64 offen offset:1024 nt lds
    v_mfma_f32_16x16x32_bf16 v[160:163], a[144:147], v[64:67], v[160:163]
    v_exp_f32 v21, v21
    v_mfma_f32_16x16x32_bf16 v[192:195], a[144:147], v[68:71], v[192:195]
    ds_read_b64_tr_b16 a[144:145], v5 offset:2048
    v_cvt_pk_bf16_f32 v58, v20, v21
    v_mfma_f32_16x16x32_bf16 v[196:199], a[148:151], v[68:71], v[196:199]
    v_exp_f32 v22, v22
    v_mfma_f32_16x16x32_bf16 v[164:167], a[148:151], v[64:67], v[164:167]
    buffer_load_dwordx4 v1, s[20:23], s65 offen offset:2048 nt lds
    v_mfma_f32_16x16x32_bf16 v[168:171], a[152:155], v[64:67], v[168:171]
    v_exp_f32 v23, v23
    v_mfma_f32_16x16x32_bf16 v[200:203], a[152:155], v[68:71], v[200:203]
    ds_read_b64_tr_b16 a[146:147], v5 offset:3072
    v_cvt_pk_bf16_f32 v59, v22, v23
    v_mfma_f32_16x16x32_bf16 v[204:207], a[156:159], v[68:71], v[204:207]
    buffer_load_dwordx4 v1, s[20:23], s65 offen offset:3072 nt lds
    v_mfma_f32_16x16x32_bf16 v[172:175], a[156:159], v[64:67], v[172:175]
    s_mov_b32 s65, s64
    v_exp_f32 v24, v24
    v_mfma_f32_16x16x32_bf16 v[176:179], a[160:163], v[64:67], v[176:179]
    s_add_u32 s31, s31, 8192
    ds_read_b64_tr_b16 a[148:149], v5 offset:2080
    ds_read_b64_tr_b16 a[150:151], v5 offset:3104
    v_mfma_f32_16x16x32_bf16 v[208:211], a[160:163], v[68:71], v[208:211]
    s_or_b32 s31, s31, s67
    v_exp_f32 v25, v25
    v_mfma_f32_16x16x32_bf16 v[212:215], a[164:167], v[68:71], v[212:215]
    s_xor_b32 s64, s31, s66
    ds_read_b64_tr_b16 a[152:153], v5 offset:2304
    v_cvt_pk_bf16_f32 v60, v24, v25
    v_mfma_f32_16x16x32_bf16 v[180:183], a[164:167], v[64:67], v[180:183]
    s_add_u32 m0, s30, s32
    v_exp_f32 v26, v26
    v_mfma_f32_16x16x32_bf16 v[184:187], a[168:171], v[64:67], v[184:187]
    s_add_u32 s30, s30, 16512
    ds_read_b64_tr_b16 a[154:155], v5 offset:3328
    ds_read_b64_tr_b16 a[156:157], v5 offset:2336
    v_mfma_f32_16x16x32_bf16 v[216:219], a[168:171], v[68:71], v[216:219]
    s_cmp_eq_u32 s30, 82560
    v_exp_f32 v27, v27
    v_mfma_f32_16x16x32_bf16 v[220:223], a[172:175], v[68:71], v[220:223]
    s_cselect_b32 s30, 0, s30
    ds_read_b64_tr_b16 a[158:159], v5 offset:3360
    v_cvt_pk_bf16_f32 v61, v26, v27
    v_mfma_f32_16x16x32_bf16 v[188:191], a[172:175], v[64:67], v[188:191]
    v_exp_f32 v28, v28
    v_mfma_f32_16x16x32_bf16 v[32:35], a[112:115], a[64:67], v[84:87]
    ds_read_b64_tr_b16 a[160:161], v5 offset:2560
    ds_read_b64_tr_b16 a[162:163], v5 offset:3584
    v_mfma_f32_16x16x32_bf16 v[32:35], a[116:119], a[68:71], v[32:35]
    v_exp_f32 v29, v29
    v_mfma_f32_16x16x32_bf16 v[32:35], a[120:123], a[72:75], v[32:35]
    ds_read_b64_tr_b16 a[164:165], v5 offset:2592
    v_cvt_pk_bf16_f32 v62, v28, v29
    v_mfma_f32_16x16x32_bf16 v[32:35], a[124:127], a[76:79], v[32:35]
    v_exp_f32 v30, v30
    v_mfma_f32_16x16x32_bf16 v[36:39], a[128:131], a[64:67], v[84:87]
    ds_read_b64_tr_b16 a[166:167], v5 offset:3616
    ds_read_b64_tr_b16 a[168:169], v5 offset:2816
    v_mfma_f32_16x16x32_bf16 v[36:39], a[132:135], a[68:71], v[36:39]
    v_exp_f32 v31, v31
    v_mfma_f32_16x16x32_bf16 v[36:39], a[136:139], a[72:75], v[36:39]
    ds_read_b64_tr_b16 a[170:171], v5 offset:3840
    v_cvt_pk_bf16_f32 v63, v30, v31
    v_mfma_f32_16x16x32_bf16 v[36:39], a[140:143], a[76:79], v[36:39]
    ds_read_b64_tr_b16 a[172:173], v5 offset:2848
    ds_read_b64_tr_b16 a[174:175], v5 offset:3872
    v_mfma_f32_16x16x32_bf16 v[40:43], a[112:115], a[80:83], v[88:91]
    v_exp_f32 v32, v32
    v_mfma_f32_16x16x32_bf16 v[40:43], a[116:119], a[84:87], v[40:43]
    ds_read_b128 a[112:115], v4 offset:0
    ds_read_b128 a[116:119], v4 offset:256
    v_mfma_f32_16x16x32_bf16 v[40:43], a[120:123], a[88:91], v[40:43]
    v_exp_f32 v33, v33
    v_mfma_f32_16x16x32_bf16 v[40:43], a[124:127], a[92:95], v[40:43]
    ds_read_b128 a[120:123], v4 offset:512
    v_cvt_pk_bf16_f32 v64, v32, v33
    v_mfma_f32_16x16x32_bf16 v[44:47], a[128:131], a[80:83], v[88:91]
    v_exp_f32 v34, v34
    v_mfma_f32_16x16x32_bf16 v[44:47], a[132:135], a[84:87], v[44:47]
    ds_read_b128 a[124:127], v4 offset:768
    ds_read_b128 a[128:131], v4 offset:1024
    v_mfma_f32_16x16x32_bf16 v[44:47], a[136:139], a[88:91], v[44:47]
    v_exp_f32 v35, v35
    v_mfma_f32_16x16x32_bf16 v[44:47], a[140:143], a[92:95], v[44:47]
    ds_read_b128 a[132:135], v4 offset:1280
    v_cvt_pk_bf16_f32 v65, v34, v35
    v_mfma_f32_16x16x32_bf16 a[176:179], a[196:199], v[56:59], a[176:179]
    v_exp_f32 v36, v36
    v_mfma_f32_16x16x32_bf16 a[180:183], a[196:199], v[60:63], a[180:183]
    s_waitcnt lgkmcnt(4)
    ds_read_b128 a[136:139], v4 offset:1536
    ds_read_b128 a[140:143], v4 offset:1792
    v_mfma_f32_16x16x32_bf16 v[96:99], a[144:147], v[56:59], v[96:99]
    v_exp_f32 v37, v37
    v_mfma_f32_16x16x32_bf16 v[128:131], a[144:147], v[60:63], v[128:131]
    v_cvt_pk_bf16_f32 v66, v36, v37
    v_mfma_f32_16x16x32_bf16 v[132:135], a[148:151], v[60:63], v[132:135]
    v_exp_f32 v38, v38
    v_mfma_f32_16x16x32_bf16 v[100:103], a[148:151], v[56:59], v[100:103]
    v_add_u32 v5, s30, v3
    v_mfma_f32_16x16x32_bf16 v[104:107], a[152:155], v[56:59], v[104:107]
    v_exp_f32 v39, v39
    v_mfma_f32_16x16x32_bf16 v[136:139], a[152:155], v[60:63], v[136:139]
    v_cvt_pk_bf16_f32 v67, v38, v39
    v_mfma_f32_16x16x32_bf16 v[140:143], a[156:159], v[60:63], v[140:143]
    v_add_u32 v4, s30, v2
    v_mfma_f32_16x16x32_bf16 v[108:111], a[156:159], v[56:59], v[108:111]
    v_exp_f32 v40, v40
    v_mfma_f32_16x16x32_bf16 v[112:115], a[160:163], v[56:59], v[112:115]
    v_mfma_f32_16x16x32_bf16 v[144:147], a[160:163], v[60:63], v[144:147]
    v_exp_f32 v41, v41
    v_mfma_f32_16x16x32_bf16 v[148:151], a[164:167], v[60:63], v[148:151]
    v_cvt_pk_bf16_f32 v68, v40, v41
    v_mfma_f32_16x16x32_bf16 v[116:119], a[164:167], v[56:59], v[116:119]
    v_exp_f32 v42, v42
    v_mfma_f32_16x16x32_bf16 v[120:123], a[168:171], v[56:59], v[120:123]
    v_mfma_f32_16x16x32_bf16 v[152:155], a[168:171], v[60:63], v[152:155]
    v_exp_f32 v43, v43
    v_mfma_f32_16x16x32_bf16 v[156:159], a[172:175], v[60:63], v[156:159]
    v_cvt_pk_bf16_f32 v69, v42, v43
    v_mfma_f32_16x16x32_bf16 v[124:127], a[172:175], v[56:59], v[124:127]
    v_exp_f32 v44, v44
    v_mfma_f32_16x16x32_bf16 v[16:19], a[112:115], a[32:35], v[76:79]
    v_mfma_f32_16x16x32_bf16 v[16:19], a[116:119], a[36:39], v[16:19]
    s_waitcnt lgkmcnt(0)
    v_exp_f32 v45, v45
    v_mfma_f32_16x16x32_bf16 v[16:19], a[120:123], a[40:43], v[16:19]
    v_cvt_pk_bf16_f32 v70, v44, v45
    v_mfma_f32_16x16x32_bf16 v[16:19], a[124:127], a[44:47], v[16:19]
    v_exp_f32 v46, v46
    v_mfma_f32_16x16x32_bf16 v[20:23], a[128:131], a[32:35], v[76:79]
    v_mfma_f32_16x16x32_bf16 v[20:23], a[132:135], a[36:39], v[20:23]
    v_exp_f32 v47, v47
    v_mfma_f32_16x16x32_bf16 v[20:23], a[136:139], a[40:43], v[20:23]
    s_sub_u32 s33, s33, 1
    v_cvt_pk_bf16_f32 v71, v46, v47
    v_mfma_f32_16x16x32_bf16 v[20:23], a[140:143], a[44:47], v[20:23]
    s_cbranch_scc0 L_B0
    s_and_b32 s33, s3, 1
    s_add_u32 s33, s33, 2
    s_branch L_C0
    .p2align 12
L_pa8:
    s_branch L_wa
L_pb8:
    s_branch L_wb2
L_pg8:
L_C0:
    v_mfma_f32_16x16x32_bf16 v[24:27], a[112:115], a[48:51], v[80:83]
    v_exp_f32 v16, v16
    v_mfma_f32_16x16x32_bf16 v[24:27], a[116:119], a[52:55], v[24:27]
    v_mfma_f32_16x16x32_bf16 v[24:27], a[120:123], a[56:59], v[24:27]
    v_exp_f32 v17, v17
    v_mfma_f32_16x16x32_bf16 v[24:27], a[124:127], a[60:63], v[24:27]
    v_cvt_pk_bf16_f32 v56, v16, v17
    v_mfma_f32_16x16x32_bf16 v[28:31], a[128:131], a[48:51], v[80:83]
    v_exp_f32 v18, v18
    v_mfma_f32_16x16x32_bf16 v[28:31], a[132:135], a[52:55], v[28:31]
    v_mfma_f32_16x16x32_bf16 v[28:31], a[136:139], a[56:59], v[28:31]
    v_exp_f32 v19, v19
    v_mfma_f32_16x16x32_bf16 v[28:31], a[140:143], a[60:63], v[28:31]
    v_cvt_pk_bf16_f32 v57, v18, v19
    v_mfma_f32_16x16x32_bf16 a[184:187], a[196:199], v[64:67], a[184:187]
    v_exp_f32 v20, v20
    v_mfma_f32_16x16x32_bf16 a[188:191], a[196:199], v[68:71], a[188:191]
    s_waitcnt vmcnt(12)
    s_barrier
    v_mfma_f32_16x16x32_bf16 v[160:163], a[144:147], v[64:67], v[160:163]
    v_exp_f32 v21, v21
    v_mfma_f32_16x16x32_bf16 v[192:195], a[144:147], v[68:71], v[192:195]
    ds_read_b64_tr_b16 a[144:145], v5 offset:2048
    v_cvt_pk_bf16_f32 v58, v20, v21
    v_mfma_f32_16x16x32_bf16 v[196:199], a[148:151], v[68:71], v[196:199]
    v_exp_f32 v22, v22
    v_mfma_f32_16x16x32_bf16 v[164:167], a[148:151], v[64:67], v[164:167]
    buffer_load_dwordx4 v1, s[20:23], s65 offen offset:2048 nt lds
    v_mfma_f32_16x16x32_bf16 v[168:171], a[152:155], v[64:67], v[168:171]
    v_exp_f32 v23, v23
    v_mfma_f32_16x16x32_bf16 v[200:203], a[152:155], v[68:71], v[200:203]
    ds_read_b64_tr_b16 a[146:147], v5 offset:3072
    v_cvt_pk_bf16_f32 v59, v22, v23
    v_mfma_f32_16x16x32_bf16 v[204:207], a[156:159], v[68:71], v[204:207]
    buffer_load_dwordx4 v1, s[20:23], s65 offen offset:3072 nt lds
    v_mfma_f32_16x16x32_bf16 v[172:175], a[156:159], v[64:67], v[172:175]
    s_mov_b32 s65, s64
    v_exp_f32 v24, v24
    v_mfma_f32_16x16x32_bf16 v[176:179], a[160:163], v[64:67], v[176:179]
    s_add_u32 s31, s31, 8192
    ds_read_b64_tr_b16 a[148:149], v5 offset:2080
    ds_read_b64_tr_b16 a[150:151], v5 offset:3104
    v_mfma_f32_16x16x32_bf16 v[208:211], a[160:163], v[68:71], v[208:211]
    s_or_b32 s31, s31, s67
    v_exp_f32 v25, v25
    v_mfma_f32_16x16x32_bf16 v[212:215], a[164:167], v[68:71], v[212:215]
    s_xor_b32 s64, s31, s66
    ds_read_b64_tr_b16 a[152:153], v5 offset:2304
    ds_read_b128 v[240:243], v10 offset:0
    ds_read_b128 v[244:247], v10 offset:1088
    v_cvt_pk_bf16_f32 v60, v24, v25
    v_mfma_f32_16x16x32_bf16 v[180:183], a[164:167], v[64:67], v[180:183]
    s_cmp_ge_i32 s38, 0
    v_exp_f32 v26, v26
    v_mfma_f32_16x16x32_bf16 v[184:187], a[168:171], v[64:67], v[184:187]
    s_cselect_b32 s41, s38, s35
    ds_read_b64_tr_b16 a[154:155], v5 offset:3328
    ds_read_b64_tr_b16 a[156:157], v5 offset:2336
    v_mfma_f32_16x16x32_bf16 v[216:219], a[168:171], v[68:71], v[216:219]
    s_add_u32 s38, s38, 6144
    v_exp_f32 v27, v27
    v_mfma_f32_16x16x32_bf16 v[220:223], a[172:175], v[68:71], v[220:223]
    s_add_u32 s42, s41, 4096
    ds_read_b64_tr_b16 a[158:159], v5 offset:3360
    v_cvt_pk_bf16_f32 v61, v26, v27
    v_mfma_f32_16x16x32_bf16 v[188:191], a[172:175], v[64:67], v[188:191]
    v_exp_f32 v28, v28
    v_mfma_f32_16x16x32_bf16 v[48:51], a[112:115], a[96:99], v[92:95]
    ds_read_b64_tr_b16 a[160:161], v5 offset:2560
    ds_read_b64_tr_b16 a[162:163], v5 offset:3584
    v_mfma_f32_16x16x32_bf16 v[48:51], a[116:119], a[100:103], v[48:51]
    v_exp_f32 v29, v29
    v_mfma_f32_16x16x32_bf16 v[48:51], a[120:123], a[104:107], v[48:51]
    ds_read_b64_tr_b16 a[164:165], v5 offset:2592
    v_cvt_pk_bf16_f32 v62, v28, v29
    v_mfma_f32_16x16x32_bf16 v[48:51], a[124:127], a[108:111], v[48:51]
    v_exp_f32 v30, v30
    v_mfma_f32_16x16x32_bf16 v[52:55], a[128:131], a[96:99], v[92:95]
    ds_read_b64_tr_b16 a[166:167], v5 offset:3616
    ds_read_b64_tr_b16 a[168:169], v5 offset:2816
    v_mfma_f32_16x16x32_bf16 v[52:55], a[132:135], a[100:103], v[52:55]
    v_exp_f32 v31, v31
    v_mfma_f32_16x16x32_bf16 v[52:55], a[136:139], a[104:107], v[52:55]
    ds_read_b64_tr_b16 a[170:171], v5 offset:3840
    v_cvt_pk_bf16_f32 v63, v30, v31
    v_mfma_f32_16x16x32_bf16 v[52:55], a[140:143], a[108:111], v[52:55]
    ds_read_b64_tr_b16 a[172:173], v5 offset:2848
    ds_read_b64_tr_b16 a[174:175], v5 offset:3872
    v_mfma_f32_16x16x32_bf16 v[32:35], a[112:115], a[64:67], v[84:87]
    v_exp_f32 v48, v48
    v_mfma_f32_16x16x32_bf16 v[32:35], a[116:119], a[68:71], v[32:35]
    s_waitcnt lgkmcnt(5)
    buffer_store_dwordx4 v[240:243], v0, s[24:27], s41 offen sc0 sc1
    v_mfma_f32_16x16x32_bf16 v[32:35], a[120:123], a[72:75], v[32:35]
    v_exp_f32 v49, v49
    v_mfma_f32_16x16x32_bf16 v[32:35], a[124:127], a[76:79], v[32:35]
    ds_read_b128 v[248:251], v10 offset:2176
    v_cvt_pk_bf16_f32 v72, v48, v49
    v_mfma_f32_16x16x32_bf16 v[36:39], a[128:131], a[64:67], v[84:87]
    v_exp_f32 v50, v50
    v_mfma_f32_16x16x32_bf16 v[36:39], a[132:135], a[68:71], v[36:39]
    v_mfma_f32_16x16x32_bf16 v[36:39], a[136:139], a[72:75], v[36:39]
    v_exp_f32 v51, v51
    v_mfma_f32_16x16x32_bf16 v[36:39], a[140:143], a[76:79], v[36:39]
    v_cvt_pk_bf16_f32 v73, v50, v51
    v_mfma_f32_16x16x32_bf16 a[176:179], a[196:199], v[56:59], a[176:179]
    v_exp_f32 v52, v52
    v_mfma_f32_16x16x32_bf16 a[180:183], a[196:199], v[60:63], a[180:183]
    buffer_store_dwordx4 v[244:247], v0, s[24:27], s41 offen offset:1024 sc0 sc1
    v_mfma_f32_16x16x32_bf16 v[96:99], a[144:147], v[56:59], v[96:99]
    v_exp_f32 v53, v53
    v_mfma_f32_16x16x32_bf16 v[128:131], a[144:147], v[60:63], v[128:131]
    ds_read_b128 v[252:255], v10 offset:3264
    v_cvt_pk_bf16_f32 v74, v52, v53
    v_mfma_f32_16x16x32_bf16 v[132:135], a[148:151], v[60:63], v[132:135]
    v_exp_f32 v54, v54
    v_mfma_f32_16x16x32_bf16 v[100:103], a[148:151], v[56:59], v[100:103]
    v_mfma_f32_16x16x32_bf16 v[104:107], a[152:155], v[56:59], v[104:107]
    v_exp_f32 v55, v55
    v_mfma_f32_16x16x32_bf16 v[136:139], a[152:155], v[60:63], v[136:139]
    v_cvt_pk_bf16_f32 v75, v54, v55
    v_mfma_f32_16x16x32_bf16 v[140:143], a[156:159], v[60:63], v[140:143]
    s_waitcnt lgkmcnt(1)
    buffer_store_dwordx4 v[248:251], v0, s[24:27], s41 offen offset:2048 sc0 sc1
    v_mfma_f32_16x16x32_bf16 v[108:111], a[156:159], v[56:59], v[108:111]
    v_exp_f32 v32, v32
    v_mfma_f32_16x16x32_bf16 v[112:115], a[160:163], v[56:59], v[112:115]
    ds_read_b128 v[224:227], v10 offset:4352
    v_mfma_f32_16x16x32_bf16 v[144:147], a[160:163], v[60:63], v[144:147]
    v_exp_f32 v33, v33
    v_mfma_f32_16x16x32_bf16 v[148:151], a[164:167], v[60:63], v[148:151]
    v_cvt_pk_bf16_f32 v64, v32, v33
    v_mfma_f32_16x16x32_bf16 v[116:119], a[164:167], v[56:59], v[116:119]
    v_exp_f32 v34, v34
    v_mfma_f32_16x16x32_bf16 v[120:123], a[168:171], v[56:59], v[120:123]
    s_waitcnt lgkmcnt(1)
    buffer_store_dwordx4 v[252:255], v0, s[24:27], s41 offen offset:3072 sc0 sc1
    v_mfma_f32_16x16x32_bf16 v[152:155], a[168:171], v[60:63], v[152:155]
    v_exp_f32 v35, v35
    v_mfma_f32_16x16x32_bf16 v[156:159], a[172:175], v[60:63], v[156:159]
    ds_read_b128 v[228:231], v10 offset:5440
    v_cvt_pk_bf16_f32 v65, v34, v35
    v_mfma_f32_16x16x32_bf16 v[124:127], a[172:175], v[56:59], v[124:127]
    v_exp_f32 v36, v36
    v_mfma_f32_16x16x32_bf16 v[40:43], a[112:115], a[80:83], v[88:91]
    ds_read_b128 a[112:115], v4 offset:0
    v_mfma_f32_16x16x32_bf16 v[40:43], a[116:119], a[84:87], v[40:43]
    v_exp_f32 v37, v37
    v_mfma_f32_16x16x32_bf16 v[40:43], a[120:123], a[88:91], v[40:43]
    ds_read_b128 a[116:119], v4 offset:256
    v_cvt_pk_bf16_f32 v66, v36, v37
    v_mfma_f32_16x16x32_bf16 v[40:43], a[124:127], a[92:95], v[40:43]
    v_exp_f32 v38, v38
    v_mfma_f32_16x16x32_bf16 v[44:47], a[128:131], a[80:83], v[88:91]
    ds_read_b128 a[120:123], v4 offset:512
    ds_read_b128 a[124:127], v4 offset:768
    v_mfma_f32_16x16x32_bf16 v[44:47], a[132:135], a[84:87], v[44:47]
    v_exp_f32 v39, v39
    v_mfma_f32_16x16x32_bf16 v[44:47], a[136:139], a[88:91], v[44:47]
    ds_read_b128 a[128:131], v4 offset:1024
    v_cvt_pk_bf16_f32 v67, v38, v39
    v_mfma_f32_16x16x32_bf16 v[44:47], a[140:143], a[92:95], v[44:47]
    ds_read_b128 a[132:135], v4 offset:1280
    ds_read_b128 a[136:139], v4 offset:1536
    v_mfma_f32_16x16x32_bf16 a[192:195], a[196:199], v[72:75], a[192:195]
    v_exp_f32 v40, v40
    v_mfma_f32_16x16x32_bf16 a[0:3], a[144:147], v[72:75], a[0:3]
    s_waitcnt lgkmcnt(5)
    ds_read_b128 a[140:143], v4 offset:1792
    buffer_store_dwordx4 v[224:227], v0, s[24:27], s42 offen sc0 sc1
    v_mfma_f32_16x16x32_bf16 a[4:7], a[148:151], v[72:75], a[4:7]
    v_exp_f32 v41, v41
    v_mfma_f32_16x16x32_bf16 a[8:11], a[152:155], v[72:75], a[8:11]
    v_cvt_pk_bf16_f32 v68, v40, v41
    v_mfma_f32_16x16x32_bf16 a[12:15], a[156:159], v[72:75], a[12:15]
    v_exp_f32 v42, v42
    v_mfma_f32_16x16x32_bf16 a[16:19], a[160:163], v[72:75], a[16:19]
    buffer_store_dwordx4 v[228:231], v0, s[24:27], s42 offen offset:1024 sc0 sc1
    v_mfma_f32_16x16x32_bf16 a[20:23], a[164:167], v[72:75], a[20:23]
    v_exp_f32 v43, v43
    v_mfma_f32_16x16x32_bf16 a[24:27], a[168:171], v[72:75], a[24:27]
    v_cvt_pk_bf16_f32 v69, v42, v43
    v_mfma_f32_16x16x32_bf16 a[28:31], a[172:175], v[72:75], a[28:31]
    v_exp_f32 v44, v44
    v_mfma_f32_16x16x32_bf16 v[16:19], a[112:115], a[32:35], v[76:79]
    v_add_u32 v10, 6528, v10
    v_mfma_f32_16x16x32_bf16 v[16:19], a[116:119], a[36:39], v[16:19]
    s_waitcnt lgkmcnt(0)
    s_add_u32 m0, s30, s32
    v_exp_f32 v45, v45
    v_mfma_f32_16x16x32_bf16 v[16:19], a[120:123], a[40:43], v[16:19]
    s_add_u32 s30, s30, 16512
    v_cvt_pk_bf16_f32 v70, v44, v45
    v_mfma_f32_16x16x32_bf16 v[16:19], a[124:127], a[44:47], v[16:19]
    s_cmp_eq_u32 s30, 82560
    v_exp_f32 v46, v46
    v_mfma_f32_16x16x32_bf16 v[20:23], a[128:131], a[32:35], v[76:79]
    s_cselect_b32 s30, 0, s30
    v_add_u32 v5, s30, v3
    v_add_u32 v4, s30, v2
    v_mfma_f32_16x16x32_bf16 v[20:23], a[132:135], a[36:39], v[20:23]
    v_exp_f32 v47, v47
    v_mfma_f32_16x16x32_bf16 v[20:23], a[136:139], a[40:43], v[20:23]
    s_sub_u32 s33, s33, 1
    v_cvt_pk_bf16_f32 v71, v46, v47
    v_mfma_f32_16x16x32_bf16 v[20:23], a[140:143], a[44:47], v[20:23]
    s_cbranch_scc1 L_Cx
    v_mfma_f32_16x16x32_bf16 v[24:27], a[112:115], a[48:51], v[80:83]
    v_exp_f32 v16, v16
    v_mfma_f32_16x16x32_bf16 v[24:27], a[116:119], a[52:55], v[24:27]
    s_waitcnt vmcnt(16)
    s_barrier
    v_mfma_f32_16x16x32_bf16 v[24:27], a[120:123], a[56:59], v[24:27]
    s_mov_b32 s65, s64
    v_exp_f32 v17, v17
    v_mfma_f32_16x16x32_bf16 v[24:27], a[124:127], a[60:63], v[24:27]
    s_add_u32 s31, s31, 8192
    v_cvt_pk_bf16_f32 v56, v16, v17
    v_mfma_f32_16x16x32_bf16 v[28:31], a[128:131], a[48:51], v[80:83]
    s_or_b32 s31, s31, s67
    v_exp_f32 v18, v18
    v_mfma_f32_16x16x32_bf16 v[28:31], a[132:135], a[52:55], v[28:31]
    s_xor_b32 s64, s31, s66
    ds_read_b128 v[240:243], v10 offset:0
    ds_read_b128 v[244:247], v10 offset:1088
    v_mfma_f32_16x16x32_bf16 v[28:31], a[136:139], a[56:59], v[28:31]
    s_cmp_ge_i32 s38, 0
    v_exp_f32 v19, v19
    v_mfma_f32_16x16x32_bf16 v[28:31], a[140:143], a[60:63], v[28:31]
    s_cselect_b32 s41, s38, s35
    v_cvt_pk_bf16_f32 v57, v18, v19
    v_mfma_f32_16x16x32_bf16 a[184:187], a[196:199], v[64:67], a[184:187]
    s_add_u32 s38, s38, 6144
    v_exp_f32 v20, v20
    v_mfma_f32_16x16x32_bf16 a[188:191], a[196:199], v[68:71], a[188:191]
    s_add_u32 s42, s41, 4096
    v_mfma_f32_16x16x32_bf16 v[160:163], a[144:147], v[64:67], v[160:163]
    v_exp_f32 v21, v21
    v_mfma_f32_16x16x32_bf16 v[192:195], a[144:147], v[68:71], v[192:195]
    ds_read_b64_tr_b16 a[144:145], v5 offset:2048
    v_cvt_pk_bf16_f32 v58, v20, v21
    v_mfma_f32_16x16x32_bf16 v[196:199], a[148:151], v[68:71], v[196:199]
    v_exp_f32 v22, v22
    v_mfma_f32_16x16x32_bf16 v[164:167], a[148:151], v[64:67], v[164:167]
    ds_read_b64_tr_b16 a[146:147], v5 offset:3072
    ds_read_b64_tr_b16 a[148:149], v5 offset:2080
    v_mfma_f32_16x16x32_bf16 v[168:171], a[152:155], v[64:67], v[168:171]
    s_waitcnt lgkmcnt(3)
    buffer_store_dwordx4 v[240:243], v0, s[24:27], s41 offen sc0 sc1
    ds_read_b128 v[248:251], v10 offset:2176
    v_exp_f32 v23, v23
    v_mfma_f32_16x16x32_bf16 v[200:203], a[152:155], v[68:71], v[200:203]
    ds_read_b64_tr_b16 a[150:151], v5 offset:3104
    v_cvt_pk_bf16_f32 v59, v22, v23
    v_mfma_f32_16x16x32_bf16 v[204:207], a[156:159], v[68:71], v[204:207]
    ds_read_b64_tr_b16 a[152:153], v5 offset:2304
    ds_read_b64_tr_b16 a[154:155], v5 offset:3328
    v_mfma_f32_16x16x32_bf16 v[172:175], a[156:159], v[64:67], v[172:175]
    v_exp_f32 v24, v24
    v_mfma_f32_16x16x32_bf16 v[176:179], a[160:163], v[64:67], v[176:179]
    ds_read_b64_tr_b16 a[156:157], v5 offset:2336
    ds_read_b64_tr_b16 a[158:159], v5 offset:3360
    buffer_store_dwordx4 v[244:247], v0, s[24:27], s41 offen offset:1024 sc0 sc1
    ds_read_b128 v[252:255], v10 offset:3264
    v_mfma_f32_16x16x32_bf16 v[208:211], a[160:163], v[68:71], v[208:211]
    v_exp_f32 v25, v25
    v_mfma_f32_16x16x32_bf16 v[212:215], a[164:167], v[68:71], v[212:215]
    ds_read_b64_tr_b16 a[160:161], v5 offset:2560
    v_cvt_pk_bf16_f32 v60, v24, v25
    v_mfma_f32_16x16x32_bf16 v[180:183], a[164:167], v[64:67], v[180:183]
    v_exp_f32 v26, v26
    v_mfma_f32_16x16x32_bf16 v[184:187], a[168:171], v[64:67], v[184:187]
    ds_read_b64_tr_b16 a[162:163], v5 offset:3584
    ds_read_b64_tr_b16 a[164:165], v5 offset:2592
    v_mfma_f32_16x16x32_bf16 v[216:219], a[168:171], v[68:71], v[216:219]
    v_exp_f32 v27, v27
    v_mfma_f32_16x16x32_bf16 v[220:223], a[172:175], v[68:71], v[220:223]
    ds_read_b64_tr_b16 a[166:167], v5 offset:3616
    v_cvt_pk_bf16_f32 v61, v26, v27
    v_mfma_f32_16x16x32_bf16 v[188:191], a[172:175], v[64:67], v[188:191]
    v_exp_f32 v28, v28
    v_mfma_f32_16x16x32_bf16 v[32:35], a[112:115], a[64:67], v[84:87]
    ds_read_b64_tr_b16 a[168:169], v5 offset:2816
    ds_read_b64_tr_b16 a[170:171], v5 offset:3840
    v_mfma_f32_16x16x32_bf16 v[32:35], a[116:119], a[68:71], v[32:35]
    v_exp_f32 v29, v29
    v_mfma_f32_16x16x32_bf16 v[32:35], a[120:123], a[72:75], v[32:35]
    ds_read_b64_tr_b16 a[172:173], v5 offset:2848
    v_cvt_pk_bf16_f32 v62, v28, v29
    v_mfma_f32_16x16x32_bf16 v[32:35], a[124:127], a[76:79], v[32:35]
    v_exp_f32 v30, v30
    v_mfma_f32_16x16x32_bf16 v[36:39], a[128:131], a[64:67], v[84:87]
    ds_read_b64_tr_b16 a[174:175], v5 offset:3872
    v_mfma_f32_16x16x32_bf16 v[36:39], a[132:135], a[68:71], v[36:39]
    v_exp_f32 v31, v31
    v_mfma_f32_16x16x32_bf16 v[36:39], a[136:139], a[72:75], v[36:39]
    v_cvt_pk_bf16_f32 v63, v30, v31
    v_mfma_f32_16x16x32_bf16 v[36:39], a[140:143], a[76:79], v[36:39]
    s_waitcnt lgkmcnt(2)
    buffer_store_dwordx4 v[248:251], v0, s[24:27], s41 offen offset:2048 sc0 sc1
    v_mfma_f32_16x16x32_bf16 v[40:43], a[112:115], a[80:83], v[88:91]
    v_exp_f32 v32, v32
    v_mfma_f32_16x16x32_bf16 v[40:43], a[116:119], a[84:87], v[40:43]
    ds_read_b128 a[112:115], v4 offset:0
    ds_read_b128 a[116:119], v4 offset:256
    v_mfma_f32_16x16x32_bf16 v[40:43], a[120:123], a[88:91], v[40:43]
    v_exp_f32 v33, v33
    v_mfma_f32_16x16x32_bf16 v[40:43], a[124:127], a[92:95], v[40:43]
    ds_read_b128 a[120:123], v4 offset:512
    v_cvt_pk_bf16_f32 v64, v32, v33
    v_mfma_f32_16x16x32_bf16 v[44:47], a[128:131], a[80:83], v[88:91]
    v_exp_f32 v34, v34
    v_mfma_f32_16x16x32_bf16 v[44:47], a[132:135], a[84:87], v[44:47]
    ds_read_b128 a[124:127], v4 offset:768
    ds_read_b128 a[128:131], v4 offset:1024
    v_mfma_f32_16x16x32_bf16 v[44:47], a[136:139], a[88:91], v[44:47]
    v_exp_f32 v35, v35
    v_mfma_f32_16x16x32_bf16 v[44:47], a[140:143], a[92:95], v[44:47]
    ds_read_b128 a[132:135], v4 offset:1280
    v_cvt_pk_bf16_f32 v65, v34, v35
    v_mfma_f32_16x16x32_bf16 a[176:179], a[196:199], v[56:59], a[176:179]
    v_exp_f32 v36, v36
    v_mfma_f32_16x16x32_bf16 a[180:183], a[196:199], v[60:63], a[180:183]
    ds_read_b128 a[136:139], v4 offset:1536
    ds_read_b128 a[140:143], v4 offset:1792
    v_mfma_f32_16x16x32_bf16 v[96:99], a[144:147], v[56:59], v[96:99]
    v_exp_f32 v37, v37
    v_mfma_f32_16x16x32_bf16 v[128:131], a[144:147], v[60:63], v[128:131]
    ds_read_b128 v[224:227], v10 offset:4352
    v_cvt_pk_bf16_f32 v66, v36, v37
    v_mfma_f32_16x16x32_bf16 v[132:135], a[148:151], v[60:63], v[132:135]
    v_exp_f32 v38, v38
    v_mfma_f32_16x16x32_bf16 v[100:103], a[148:151], v[56:59], v[100:103]
    v_mfma_f32_16x16x32_bf16 v[104:107], a[152:155], v[56:59], v[104:107]
    v_exp_f32 v39, v39
    v_mfma_f32_16x16x32_bf16 v[136:139], a[152:155], v[60:63], v[136:139]
    v_cvt_pk_bf16_f32 v67, v38, v39
    v_mfma_f32_16x16x32_bf16 v[140:143], a[156:159], v[60:63], v[140:143]
    buffer_store_dwordx4 v[252:255], v0, s[24:27], s41 offen offset:3072 sc0 sc1
    v_mfma_f32_16x16x32_bf16 v[108:111], a[156:159], v[56:59], v[108:111]
    v_exp_f32 v40, v40
    v_mfma_f32_16x16x32_bf16 v[112:115], a[160:163], v[56:59], v[112:115]
    ds_read_b128 v[228:231], v10 offset:5440
    v_mfma_f32_16x16x32_bf16 v[144:147], a[160:163], v[60:63], v[144:147]
    v_exp_f32 v41, v41
    v_mfma_f32_16x16x32_bf16 v[148:151], a[164:167], v[60:63], v[148:151]
    v_cvt_pk_bf16_f32 v68, v40, v41
    v_mfma_f32_16x16x32_bf16 v[116:119], a[164:167], v[56:59], v[116:119]
    v_exp_f32 v42, v42
    v_mfma_f32_16x16x32_bf16 v[120:123], a[168:171], v[56:59], v[120:123]
    s_waitcnt lgkmcnt(1)
    buffer_store_dwordx4 v[224:227], v0, s[24:27], s42 offen sc0 sc1
    v_mfma_f32_16x16x32_bf16 v[152:155], a[168:171], v[60:63], v[152:155]
    v_exp_f32 v43, v43
    v_mfma_f32_16x16x32_bf16 v[156:159], a[172:175], v[60:63], v[156:159]
    v_cvt_pk_bf16_f32 v69, v42, v43
    v_mfma_f32_16x16x32_bf16 v[124:127], a[172:175], v[56:59], v[124:127]
    v_exp_f32 v44, v44
    v_mfma_f32_16x16x32_bf16 v[16:19], a[112:115], a[32:35], v[76:79]
    s_waitcnt lgkmcnt(0)
    buffer_store_dwordx4 v[228:231], v0, s[24:27], s42 offen offset:1024 sc0 sc1
    v_add_u32 v10, 6528, v10
    v_mfma_f32_16x16x32_bf16 v[16:19], a[116:119], a[36:39], v[16:19]
    s_add_u32 m0, s30, s32
    v_exp_f32 v45, v45
    v_mfma_f32_16x16x32_bf16 v[16:19], a[120:123], a[40:43], v[16:19]
    s_add_u32 s30, s30, 16512
    v_cvt_pk_bf16_f32 v70, v44, v45
    v_mfma_f32_16x16x32_bf16 v[16:19], a[124:127], a[44:47], v[16:19]
    s_cmp_eq_u32 s30, 82560
    v_exp_f32 v46, v46
    v_mfma_f32_16x16x32_bf16 v[20:23], a[128:131], a[32:35], v[76:79]
    s_cselect_b32 s30, 0, s30
    v_add_u32 v5, s30, v3
    v_add_u32 v4, s30, v2
    v_mfma_f32_16x16x32_bf16 v[20:23], a[132:135], a[36:39], v[20:23]
    v_exp_f32 v47, v47
    v_mfma_f32_16x16x32_bf16 v[20:23], a[136:139], a[40:43], v[20:23]
    s_sub_u32 s33, s33, 1
    v_cvt_pk_bf16_f32 v71, v46, v47
    v_mfma_f32_16x16x32_bf16 v[20:23], a[140:143], a[44:47], v[20:23]
    s_cbranch_scc0 L_C0
    s_branch L_E1
    .p2align 12
L_pa9:
    s_branch L_wa
L_pb9:
    s_branch L_wb2
L_pg9:
L_E1:
    v_mfma_f32_16x16x32_bf16 v[48:51], a[112:115], a[96:99], v[92:95]
    v_exp_f32 v16, v16
    v_mfma_f32_16x16x32_bf16 v[48:51], a[116:119], a[100:103], v[48:51]
    v_exp_f32 v17, v17
    v_mfma_f32_16x16x32_bf16 v[48:51], a[120:123], a[104:107], v[48:51]
    v_cvt_pk_bf16_f32 v56, v16, v17
    v_mfma_f32_16x16x32_bf16 v[48:51], a[124:127], a[108:111], v[48:51]
    v_exp_f32 v18, v18
    v_mfma_f32_16x16x32_bf16 v[52:55], a[128:131], a[96:99], v[92:95]
    v_exp_f32 v19, v19
    v_mfma_f32_16x16x32_bf16 v[52:55], a[132:135], a[100:103], v[52:55]
    v_cvt_pk_bf16_f32 v57, v18, v19
    v_mfma_f32_16x16x32_bf16 v[52:55], a[136:139], a[104:107], v[52:55]
    v_exp_f32 v20, v20
    v_mfma_f32_16x16x32_bf16 v[52:55], a[140:143], a[108:111], v[52:55]
    v_exp_f32 v21, v21
    v_mfma_f32_16x16x32_bf16 a[184:187], a[196:199], v[64:67], a[184:187]
    v_cvt_pk_bf16_f32 v58, v20, v21
    v_mfma_f32_16x16x32_bf16 a[188:191], a[196:199], v[68:71], a[188:191]
    s_barrier
    v_mfma_f32_16x16x32_bf16 v[160:163], a[144:147], v[64:67], v[160:163]
    v_exp_f32 v22, v22
    v_mfma_f32_16x16x32_bf16 v[192:195], a[144:147], v[68:71], v[192:195]
    v_exp_f32 v23, v23
    v_mfma_f32_16x16x32_bf16 v[196:199], a[148:151], v[68:71], v[196:199]
    ds_read_b64_tr_b16 a[144:145], v5 offset:2048
    v_cvt_pk_bf16_f32 v59, v22, v23
    v_mfma_f32_16x16x32_bf16 v[164:167], a[148:151], v[64:67], v[164:167]
    v_exp_f32 v48, v48
    v_mfma_f32_16x16x32_bf16 v[168:171], a[152:155], v[64:67], v[168:171]
    v_exp_f32 v49, v49
    v_mfma_f32_16x16x32_bf16 v[200:203], a[152:155], v[68:71], v[200:203]
    ds_read_b64_tr_b16 a[146:147], v5 offset:3072
    v_cvt_pk_bf16_f32 v72, v48, v49
    v_mfma_f32_16x16x32_bf16 v[204:207], a[156:159], v[68:71], v[204:207]
    v_exp_f32 v50, v50
    v_mfma_f32_16x16x32_bf16 v[172:175], a[156:159], v[64:67], v[172:175]
    v_exp_f32 v51, v51
    v_mfma_f32_16x16x32_bf16 v[176:179], a[160:163], v[64:67], v[176:179]
    ds_read_b64_tr_b16 a[148:149], v5 offset:2080
    v_cvt_pk_bf16_f32 v73, v50, v51
    v_mfma_f32_16x16x32_bf16 v[208:211], a[160:163], v[68:71], v[208:211]
    v_exp_f32 v52, v52
    v_mfma_f32_16x16x32_bf16 v[212:215], a[164:167], v[68:71], v[212:215]
    v_exp_f32 v53, v53
    v_mfma_f32_16x16x32_bf16 v[180:183], a[164:167], v[64:67], v[180:183]
    ds_read_b64_tr_b16 a[150:151], v5 offset:3104
    v_cvt_pk_bf16_f32 v74, v52, v53
    v_mfma_f32_16x16x32_bf16 v[184:187], a[168:171], v[64:67], v[184:187]
    v_exp_f32 v54, v54
    v_mfma_f32_16x16x32_bf16 v[216:219], a[168:171], v[68:71], v[216:219]
    v_exp_f32 v55, v55
    v_mfma_f32_16x16x32_bf16 v[220:223], a[172:175], v[68:71], v[220:223]
    ds_read_b64_tr_b16 a[152:153], v5 offset:2304
    v_cvt_pk_bf16_f32 v75, v54, v55
    v_mfma_f32_16x16x32_bf16 v[188:191], a[172:175], v[64:67], v[188:191]
    ds_read_b64_tr_b16 a[154:155], v5 offset:3328
    ds_read_b64_tr_b16 a[156:157], v5 offset:2336
    v_mfma_f32_16x16x32_bf16 v[24:27], a[112:115], a[48:51], v[80:83]
    ds_read_b64_tr_b16 a[158:159], v5 offset:3360
    ds_read_b64_tr_b16 a[160:161], v5 offset:2560
    v_mfma_f32_16x16x32_bf16 v[24:27], a[116:119], a[52:55], v[24:27]
    ds_read_b64_tr_b16 a[162:163], v5 offset:3584
    ds_read_b64_tr_b16 a[164:165], v5 offset:2592
    v_mfma_f32_16x16x32_bf16 v[24:27], a[120:123], a[56:59], v[24:27]
    ds_read_b64_tr_b16 a[166:167], v5 offset:3616
    ds_read_b64_tr_b16 a[168:169], v5 offset:2816
    v_mfma_f32_16x16x32_bf16 v[24:27], a[124:127], a[60:63], v[24:27]
    v_mfma_f32_16x16x32_bf16 v[28:31], a[128:131], a[48:51], v[80:83]
    v_mfma_f32_16x16x32_bf16 v[28:31], a[132:135], a[52:55], v[28:31]
    v_mfma_f32_16x16x32_bf16 v[28:31], a[136:139], a[56:59], v[28:31]
    v_mfma_f32_16x16x32_bf16 v[28:31], a[140:143], a[60:63], v[28:31]
    v_mfma_f32_16x16x32_bf16 v[32:35], a[112:115], a[64:67], v[84:87]
    s_nop 2
    v_exp_f32 v24, v24
    v_mfma_f32_16x16x32_bf16 v[32:35], a[116:119], a[68:71], v[32:35]
    v_exp_f32 v25, v25
    v_mfma_f32_16x16x32_bf16 v[32:35], a[120:123], a[72:75], v[32:35]
    ds_read_b64_tr_b16 a[170:171], v5 offset:3840
    v_cvt_pk_bf16_f32 v60, v24, v25
    v_mfma_f32_16x16x32_bf16 v[32:35], a[124:127], a[76:79], v[32:35]
    v_exp_f32 v26, v26
    v_mfma_f32_16x16x32_bf16 v[36:39], a[128:131], a[64:67], v[84:87]
    v_exp_f32 v27, v27
    v_mfma_f32_16x16x32_bf16 v[36:39], a[132:135], a[68:71], v[36:39]
    ds_read_b64_tr_b16 a[172:173], v5 offset:2848
    v_cvt_pk_bf16_f32 v61, v26, v27
    v_mfma_f32_16x16x32_bf16 v[36:39], a[136:139], a[72:75], v[36:39]
    v_exp_f32 v28, v28
    v_mfma_f32_16x16x32_bf16 v[36:39], a[140:143], a[76:79], v[36:39]
    v_exp_f32 v29, v29
    v_mfma_f32_16x16x32_bf16 a[192:195], a[196:199], v[72:75], a[192:195]
    s_waitcnt lgkmcnt(2)
    ds_read_b64_tr_b16 a[174:175], v5 offset:3872
    v_cvt_pk_bf16_f32 v62, v28, v29
    v_mfma_f32_16x16x32_bf16 a[0:3], a[144:147], v[72:75], a[0:3]
    v_exp_f32 v30, v30
    v_mfma_f32_16x16x32_bf16 a[4:7], a[148:151], v[72:75], a[4:7]
    v_exp_f32 v31, v31
    v_mfma_f32_16x16x32_bf16 a[8:11], a[152:155], v[72:75], a[8:11]
    v_cvt_pk_bf16_f32 v63, v30, v31
    v_accvgpr_read_b32 v10, a226
    v_mfma_f32_16x16x32_bf16 a[12:15], a[156:159], v[72:75], a[12:15]
    s_lshr_b32 s42, s3, 1
    v_exp_f32 v32, v32
    v_mfma_f32_16x16x32_bf16 a[16:19], a[160:163], v[72:75], a[16:19]
    s_mul_i32 s43, s42, 39168
    v_exp_f32 v33, v33
    v_mfma_f32_16x16x32_bf16 a[20:23], a[164:167], v[72:75], a[20:23]
    s_waitcnt lgkmcnt(1)
    v_cvt_pk_bf16_f32 v64, v32, v33
    v_bfe_u32 v50, v0, 7, 3
    v_and_b32 v51, 0x70, v0
    v_mul_u32_u24 v48, 272, v50
    v_lshl_add_u32 v49, v50, 8, v51
    v_add3_u32 v48, v48, v51, s43
    v_mfma_f32_16x16x32_bf16 a[24:27], a[168:171], v[72:75], a[24:27]
    s_waitcnt lgkmcnt(0)
    v_exp_f32 v34, v34
    v_mfma_f32_16x16x32_bf16 a[28:31], a[172:175], v[72:75], a[28:31]
    v_exp_f32 v35, v35
    v_mfma_f32_16x16x32_bf16 v[40:43], a[112:115], a[80:83], v[88:91]
    v_cvt_pk_bf16_f32 v65, v34, v35
    v_add_u32 v48, 100096, v48
    v_mfma_f32_16x16x32_bf16 v[40:43], a[116:119], a[84:87], v[40:43]
    s_mul_i32 s42, s42, 36864
    v_exp_f32 v36, v36
    v_mfma_f32_16x16x32_bf16 v[40:43], a[120:123], a[88:91], v[40:43]
    s_add_u32 s42, s42, 18890880
    v_exp_f32 v37, v37
    v_mfma_f32_16x16x32_bf16 v[40:43], a[124:127], a[92:95], v[40:43]
    ds_write_b128 v12, a[0:3] offset:0
    ds_write_b128 v12, a[4:7] offset:1024
    v_cvt_pk_bf16_f32 v66, v36, v37
    v_mfma_f32_16x16x32_bf16 v[44:47], a[128:131], a[80:83], v[88:91]
    v_exp_f32 v38, v38
    v_mfma_f32_16x16x32_bf16 v[44:47], a[132:135], a[84:87], v[44:47]
    v_exp_f32 v39, v39
    v_mfma_f32_16x16x32_bf16 v[44:47], a[136:139], a[88:91], v[44:47]
    ds_write_b128 v12, a[8:11] offset:2048
    v_cvt_pk_bf16_f32 v67, v38, v39
    v_mfma_f32_16x16x32_bf16 v[44:47], a[140:143], a[92:95], v[44:47]
    ds_write_b128 v12, a[12:15] offset:3072
    v_mfma_f32_16x16x32_bf16 a[176:179], a[196:199], v[56:59], a[176:179]
    v_exp_f32 v40, v40
    v_mfma_f32_16x16x32_bf16 v[96:99], a[144:147], v[56:59], v[96:99]
    v_exp_f32 v41, v41
    v_mfma_f32_16x16x32_bf16 v[100:103], a[148:151], v[56:59], v[100:103]
    ds_write_b32 v13, a192 offset:0
    v_cvt_pk_bf16_f32 v68, v40, v41
    v_mfma_f32_16x16x32_bf16 v[104:107], a[152:155], v[56:59], v[104:107]
    v_exp_f32 v42, v42
    v_mfma_f32_16x16x32_bf16 v[108:111], a[156:159], v[56:59], v[108:111]
    s_waitcnt lgkmcnt(0)
    s_barrier
    v_mfma_f32_16x16x32_bf16 v[112:115], a[160:163], v[56:59], v[112:115]
    ds_read_b128 v[240:243], v12 offset:4128
    ds_read_b128 v[244:247], v12 offset:5152
    ds_read_b128 v[248:251], v12 offset:6176
    ds_read_b128 v[252:255], v12 offset:7200
    v_exp_f32 v43, v43
    v_mfma_f32_16x16x32_bf16 v[116:119], a[164:167], v[56:59], v[116:119]
    ds_read_b32 v232, v13 offset:64
    v_cvt_pk_bf16_f32 v69, v42, v43
    v_mfma_f32_16x16x32_bf16 v[120:123], a[168:171], v[56:59], v[120:123]
    v_exp_f32 v44, v44
    v_mfma_f32_16x16x32_bf16 v[124:127], a[172:175], v[56:59], v[124:127]
    v_exp_f32 v45, v45
    v_mfma_f32_16x16x32_bf16 a[180:183], a[196:199], v[60:63], a[180:183]
    v_cvt_pk_bf16_f32 v70, v44, v45
    v_mfma_f32_16x16x32_bf16 v[128:131], a[144:147], v[60:63], v[128:131]
    v_exp_f32 v46, v46
    v_mfma_f32_16x16x32_bf16 v[132:135], a[148:151], v[60:63], v[132:135]
    s_waitcnt lgkmcnt(0)
    v_exp_f32 v47, v47
    v_accvgpr_read_b32 v233, a192
    v_add_f32 v232, v232, v233
    v_rcp_f32 v234, v232
    v_add_f32 v14, v14, v232
    v_accvgpr_read_b32 v228, a16
    v_accvgpr_read_b32 v229, a17
    v_accvgpr_read_b32 v230, a18
    v_accvgpr_read_b32 v231, a19
    v_mfma_f32_16x16x32_bf16 v[136:139], a[152:155], v[60:63], v[136:139]
    v_cvt_pk_bf16_f32 v71, v46, v47
    v_pk_add_f32 v[240:241], v[240:241], v[228:229]
    v_pk_add_f32 v[242:243], v[242:243], v[230:231]
    v_pk_mul_f32 v[240:241], v[240:241], v[234:235] op_sel_hi:[1,0]
    v_pk_mul_f32 v[242:243], v[242:243], v[234:235] op_sel_hi:[1,0]
    v_cvt_pk_bf16_f32 v240, v240, v241
    v_cvt_pk_bf16_f32 v241, v242, v243
    v_mfma_f32_16x16x32_bf16 v[140:143], a[156:159], v[60:63], v[140:143]
    ds_write_b64 v9, v[240:241] offset:128
    v_accvgpr_read_b32 v228, a20
    v_accvgpr_read_b32 v229, a21
    v_accvgpr_read_b32 v230, a22
    v_accvgpr_read_b32 v231, a23
    v_pk_add_f32 v[244:245], v[244:245], v[228:229]
    v_pk_add_f32 v[246:247], v[246:247], v[230:231]
    v_pk_mul_f32 v[244:245], v[244:245], v[234:235] op_sel_hi:[1,0]
    v_pk_mul_f32 v[246:247], v[246:247], v[234:235] op_sel_hi:[1,0]
    v_cvt_pk_bf16_f32 v244, v244, v245
    v_cvt_pk_bf16_f32 v245, v246, v247
    v_mfma_f32_16x16x32_bf16 v[144:147], a[160:163], v[60:63], v[144:147]
    ds_write_b64 v9, v[244:245] offset:160
    v_accvgpr_read_b32 v228, a24
    v_accvgpr_read_b32 v229, a25
    v_accvgpr_read_b32 v230, a26
    v_accvgpr_read_b32 v231, a27
    v_pk_add_f32 v[248:249], v[248:249], v[228:229]
    v_pk_add_f32 v[250:251], v[250:251], v[230:231]
    v_pk_mul_f32 v[248:249], v[248:249], v[234:235] op_sel_hi:[1,0]
    v_pk_mul_f32 v[250:251], v[250:251], v[234:235] op_sel_hi:[1,0]
    v_cvt_pk_bf16_f32 v248, v248, v249
    v_cvt_pk_bf16_f32 v249, v250, v251
    v_mfma_f32_16x16x32_bf16 v[148:151], a[164:167], v[60:63], v[148:151]
    ds_write_b64 v9, v[248:249] offset:192
    v_accvgpr_read_b32 v228, a28
    v_accvgpr_read_b32 v229, a29
    v_accvgpr_read_b32 v230, a30
    v_accvgpr_read_b32 v231, a31
    v_pk_add_f32 v[252:253], v[252:253], v[228:229]
    v_pk_add_f32 v[254:255], v[254:255], v[230:231]
    v_pk_mul_f32 v[252:253], v[252:253], v[234:235] op_sel_hi:[1,0]
    v_pk_mul_f32 v[254:255], v[254:255], v[234:235] op_sel_hi:[1,0]
    v_cvt_pk_bf16_f32 v252, v252, v253
    v_cvt_pk_bf16_f32 v253, v254, v255
    v_mfma_f32_16x16x32_bf16 v[152:155], a[168:171], v[60:63], v[152:155]
    ds_write_b64 v9, v[252:253] offset:224
    ds_read_b128 v[240:243], v48 offset:0
    ds_read_b128 v[244:247], v48 offset:2176
    v_accvgpr_read_b32 v225, a176
    v_mfma_f32_16x16x32_bf16 v[156:159], a[172:175], v[60:63], v[156:159]
    v_rcp_f32 v224, v225
    v_add_f32 v14, v14, v225
    v_mfma_f32_16x16x32_bf16 a[184:187], a[196:199], v[64:67], a[184:187]
    v_pk_mul_f32 v[96:97], v[96:97], v[224:225] op_sel_hi:[1,0]
    v_pk_mul_f32 v[98:99], v[98:99], v[224:225] op_sel_hi:[1,0]
    v_pk_mul_f32 v[100:101], v[100:101], v[224:225] op_sel_hi:[1,0]
    v_pk_mul_f32 v[102:103], v[102:103], v[224:225] op_sel_hi:[1,0]
    v_pk_mul_f32 v[104:105], v[104:105], v[224:225] op_sel_hi:[1,0]
    v_pk_mul_f32 v[106:107], v[106:107], v[224:225] op_sel_hi:[1,0]
    v_pk_mul_f32 v[108:109], v[108:109], v[224:225] op_sel_hi:[1,0]
    v_pk_mul_f32 v[110:111], v[110:111], v[224:225] op_sel_hi:[1,0]
    v_pk_mul_f32 v[112:113], v[112:113], v[224:225] op_sel_hi:[1,0]
    v_pk_mul_f32 v[114:115], v[114:115], v[224:225] op_sel_hi:[1,0]
    v_pk_mul_f32 v[116:117], v[116:117], v[224:225] op_sel_hi:[1,0]
    v_pk_mul_f32 v[118:119], v[118:119], v[224:225] op_sel_hi:[1,0]
    v_pk_mul_f32 v[120:121], v[120:121], v[224:225] op_sel_hi:[1,0]
    v_pk_mul_f32 v[122:123], v[122:123], v[224:225] op_sel_hi:[1,0]
    v_pk_mul_f32 v[124:125], v[124:125], v[224:225] op_sel_hi:[1,0]
    v_pk_mul_f32 v[126:127], v[126:127], v[224:225] op_sel_hi:[1,0]
    v_cvt_pk_bf16_f32 v96, v96, v97
    v_cvt_pk_bf16_f32 v97, v98, v99
    v_mfma_f32_16x16x32_bf16 v[160:163], a[144:147], v[64:67], v[160:163]
    ds_write_b64 v8, v[96:97] offset:0
    v_cvt_pk_bf16_f32 v100, v100, v101
    v_cvt_pk_bf16_f32 v101, v102, v103
    v_mfma_f32_16x16x32_bf16 v[164:167], a[148:151], v[64:67], v[164:167]
    ds_write_b64 v8, v[100:101] offset:32
    v_cvt_pk_bf16_f32 v104, v104, v105
    v_cvt_pk_bf16_f32 v105, v106, v107
    v_mfma_f32_16x16x32_bf16 v[168:171], a[152:155], v[64:67], v[168:171]
    ds_write_b64 v8, v[104:105] offset:64
    v_cvt_pk_bf16_f32 v108, v108, v109
    v_cvt_pk_bf16_f32 v109, v110, v111
    v_mfma_f32_16x16x32_bf16 v[172:175], a[156:159], v[64:67], v[172:175]
    ds_write_b64 v8, v[108:109] offset:96
    v_mfma_f32_16x16x32_bf16 v[176:179], a[160:163], v[64:67], v[176:179]
    v_cvt_pk_bf16_f32 v112, v112, v113
    v_cvt_pk_bf16_f32 v113, v114, v115
    v_mfma_f32_16x16x32_bf16 v[180:183], a[164:167], v[64:67], v[180:183]
    ds_write_b64 v8, v[112:113] offset:128
    v_mfma_f32_16x16x32_bf16 v[184:187], a[168:171], v[64:67], v[184:187]
    v_cvt_pk_bf16_f32 v116, v116, v117
    v_cvt_pk_bf16_f32 v117, v118, v119
    v_mfma_f32_16x16x32_bf16 v[188:191], a[172:175], v[64:67], v[188:191]
    ds_write_b64 v8, v[116:117] offset:160
    v_mfma_f32_16x16x32_bf16 a[188:191], a[196:199], v[68:71], a[188:191]
    v_cvt_pk_bf16_f32 v120, v120, v121
    v_cvt_pk_bf16_f32 v121, v122, v123
    v_mfma_f32_16x16x32_bf16 v[192:195], a[144:147], v[68:71], v[192:195]
    ds_write_b64 v8, v[120:121] offset:192
    v_mfma_f32_16x16x32_bf16 v[196:199], a[148:151], v[68:71], v[196:199]
    v_cvt_pk_bf16_f32 v124, v124, v125
    v_cvt_pk_bf16_f32 v125, v126, v127
    v_mfma_f32_16x16x32_bf16 v[200:203], a[152:155], v[68:71], v[200:203]
    ds_write_b64 v8, v[124:125] offset:224
    v_mfma_f32_16x16x32_bf16 v[204:207], a[156:159], v[68:71], v[204:207]
    s_waitcnt lgkmcnt(3)
    buffer_store_dwordx4 v[240:243], v49, s[24:27], s42 offen sc0 sc1
    v_mfma_f32_16x16x32_bf16 v[208:211], a[160:163], v[68:71], v[208:211]
    buffer_store_dwordx4 v[244:247], v49, s[24:27], s42 offen offset:2048 sc0 sc1
    ds_read_b128 v[96:99], v10 offset:2176
    v_mfma_f32_16x16x32_bf16 v[212:215], a[164:167], v[68:71], v[212:215]
    ds_read_b128 v[100:103], v10 offset:3264
    ds_read_b128 v[104:107], v10 offset:4352
    v_mfma_f32_16x16x32_bf16 v[216:219], a[168:171], v[68:71], v[216:219]
    ds_read_b128 v[108:111], v10 offset:5440
    v_accvgpr_read_b32 v227, a180
    v_mfma_f32_16x16x32_bf16 v[220:223], a[172:175], v[68:71], v[220:223]
    v_rcp_f32 v226, v227
    v_add_f32 v14, v14, v227
    v_pk_mul_f32 v[128:129], v[128:129], v[226:227] op_sel_hi:[1,0]
    v_pk_mul_f32 v[130:131], v[130:131], v[226:227] op_sel_hi:[1,0]
    v_pk_mul_f32 v[132:133], v[132:133], v[226:227] op_sel_hi:[1,0]
    v_pk_mul_f32 v[134:135], v[134:135], v[226:227] op_sel_hi:[1,0]
    v_pk_mul_f32 v[136:137], v[136:137], v[226:227] op_sel_hi:[1,0]
    v_pk_mul_f32 v[138:139], v[138:139], v[226:227] op_sel_hi:[1,0]
    v_pk_mul_f32 v[140:141], v[140:141], v[226:227] op_sel_hi:[1,0]
    v_pk_mul_f32 v[142:143], v[142:143], v[226:227] op_sel_hi:[1,0]
    v_pk_mul_f32 v[144:145], v[144:145], v[226:227] op_sel_hi:[1,0]
    v_pk_mul_f32 v[146:147], v[146:147], v[226:227] op_sel_hi:[1,0]
    v_pk_mul_f32 v[148:149], v[148:149], v[226:227] op_sel_hi:[1,0]
    v_pk_mul_f32 v[150:151], v[150:151], v[226:227] op_sel_hi:[1,0]
    v_pk_mul_f32 v[152:153], v[152:153], v[226:227] op_sel_hi:[1,0]
    v_pk_mul_f32 v[154:155], v[154:155], v[226:227] op_sel_hi:[1,0]
    v_pk_mul_f32 v[156:157], v[156:157], v[226:227] op_sel_hi:[1,0]
    v_pk_mul_f32 v[158:159], v[158:159], v[226:227] op_sel_hi:[1,0]
    v_cvt_pk_bf16_f32 v128, v128, v129
    v_cvt_pk_bf16_f32 v129, v130, v131
    ds_write_b64 v8, v[128:129] offset:4352
    v_cvt_pk_bf16_f32 v132, v132, v133
    v_cvt_pk_bf16_f32 v133, v134, v135
    ds_write_b64 v8, v[132:133] offset:4384
    v_cvt_pk_bf16_f32 v136, v136, v137
    v_cvt_pk_bf16_f32 v137, v138, v139
    ds_write_b64 v8, v[136:137] offset:4416
    v_cvt_pk_bf16_f32 v140, v140, v141
    v_cvt_pk_bf16_f32 v141, v142, v143
    ds_write_b64 v8, v[140:141] offset:4448
    v_cvt_pk_bf16_f32 v144, v144, v145
    v_cvt_pk_bf16_f32 v145, v146, v147
    ds_write_b64 v8, v[144:145] offset:4480
    v_cvt_pk_bf16_f32 v148, v148, v149
    v_cvt_pk_bf16_f32 v149, v150, v151
    ds_write_b64 v8, v[148:149] offset:4512
    v_cvt_pk_bf16_f32 v152, v152, v153
    v_cvt_pk_bf16_f32 v153, v154, v155
    ds_write_b64 v8, v[152:153] offset:4544
    v_cvt_pk_bf16_f32 v156, v156, v157
    v_cvt_pk_bf16_f32 v157, v158, v159
    ds_write_b64 v8, v[156:157] offset:4576
    s_waitcnt lgkmcnt(6)
    s_mov_b32 s41, 18876416
    buffer_store_dwordx4 v[96:99], v0, s[24:27], s41 offen sc0 sc1
    buffer_store_dwordx4 v[100:103], v0, s[24:27], s41 offen offset:1024 sc0 sc1
    buffer_store_dwordx4 v[104:107], v0, s[24:27], s41 offen offset:2048 sc0 sc1
    buffer_store_dwordx4 v[108:111], v0, s[24:27], s41 offen offset:3072 sc0 sc1
    ds_read_b128 v[128:131], v10 offset:6528
    ds_read_b128 v[132:135], v10 offset:7616
    ds_read_b128 v[136:139], v10 offset:8704
    ds_read_b128 v[140:143], v10 offset:9792
    v_accvgpr_read_b32 v225, a184
    v_rcp_f32 v224, v225
    v_add_f32 v14, v14, v225
    v_pk_mul_f32 v[160:161], v[160:161], v[224:225] op_sel_hi:[1,0]
    v_pk_mul_f32 v[162:163], v[162:163], v[224:225] op_sel_hi:[1,0]
    v_pk_mul_f32 v[164:165], v[164:165], v[224:225] op_sel_hi:[1,0]
    v_pk_mul_f32 v[166:167], v[166:167], v[224:225] op_sel_hi:[1,0]
    v_pk_mul_f32 v[168:169], v[168:169], v[224:225] op_sel_hi:[1,0]
    v_pk_mul_f32 v[170:171], v[170:171], v[224:225] op_sel_hi:[1,0]
    v_pk_mul_f32 v[172:173], v[172:173], v[224:225] op_sel_hi:[1,0]
    v_pk_mul_f32 v[174:175], v[174:175], v[224:225] op_sel_hi:[1,0]
    v_pk_mul_f32 v[176:177], v[176:177], v[224:225] op_sel_hi:[1,0]
    v_pk_mul_f32 v[178:179], v[178:179], v[224:225] op_sel_hi:[1,0]
    v_pk_mul_f32 v[180:181], v[180:181], v[224:225] op_sel_hi:[1,0]
    v_pk_mul_f32 v[182:183], v[182:183], v[224:225] op_sel_hi:[1,0]
    v_pk_mul_f32 v[184:185], v[184:185], v[224:225] op_sel_hi:[1,0]
    v_pk_mul_f32 v[186:187], v[186:187], v[224:225] op_sel_hi:[1,0]
    v_pk_mul_f32 v[188:189], v[188:189], v[224:225] op_sel_hi:[1,0]
    v_pk_mul_f32 v[190:191], v[190:191], v[224:225] op_sel_hi:[1,0]
    v_cvt_pk_bf16_f32 v160, v160, v161
    v_cvt_pk_bf16_f32 v161, v162, v163
    ds_write_b64 v8, v[160:161] offset:8704
    v_cvt_pk_bf16_f32 v164, v164, v165
    v_cvt_pk_bf16_f32 v165, v166, v167
    ds_write_b64 v8, v[164:165] offset:8736
    v_cvt_pk_bf16_f32 v168, v168, v169
    v_cvt_pk_bf16_f32 v169, v170, v171
    ds_write_b64 v8, v[168:169] offset:8768
    v_cvt_pk_bf16_f32 v172, v172, v173
    v_cvt_pk_bf16_f32 v173, v174, v175
    ds_write_b64 v8, v[172:173] offset:8800
    v_cvt_pk_bf16_f32 v176, v176, v177
    v_cvt_pk_bf16_f32 v177, v178, v179
    ds_write_b64 v8, v[176:177] offset:8832
    v_cvt_pk_bf16_f32 v180, v180, v181
    v_cvt_pk_bf16_f32 v181, v182, v183
    ds_write_b64 v8, v[180:181] offset:8864
    v_cvt_pk_bf16_f32 v184, v184, v185
    v_cvt_pk_bf16_f32 v185, v186, v187
    ds_write_b64 v8, v[184:185] offset:8896
    v_cvt_pk_bf16_f32 v188, v188, v189
    v_cvt_pk_bf16_f32 v189, v190, v191
    ds_write_b64 v8, v[188:189] offset:8928
    s_waitcnt lgkmcnt(6)
    s_mov_b32 s41, 18880512
    buffer_store_dwordx4 v[128:131], v0, s[24:27], s41 offen sc0 sc1
    buffer_store_dwordx4 v[132:135], v0, s[24:27], s41 offen offset:1024 sc0 sc1
    buffer_store_dwordx4 v[136:139], v0, s[24:27], s41 offen offset:2048 sc0 sc1
    buffer_store_dwordx4 v[140:143], v0, s[24:27], s41 offen offset:3072 sc0 sc1
    ds_read_b128 v[160:163], v10 offset:10880
    ds_read_b128 v[164:167], v10 offset:11968
    ds_read_b128 v[168:171], v10 offset:13056
    ds_read_b128 v[172:175], v10 offset:14144
    v_accvgpr_read_b32 v227, a188
    v_rcp_f32 v226, v227
    v_add_f32 v14, v14, v227
    v_pk_mul_f32 v[192:193], v[192:193], v[226:227] op_sel_hi:[1,0]
    v_pk_mul_f32 v[194:195], v[194:195], v[226:227] op_sel_hi:[1,0]
    v_pk_mul_f32 v[196:197], v[196:197], v[226:227] op_sel_hi:[1,0]
    v_pk_mul_f32 v[198:199], v[198:199], v[226:227] op_sel_hi:[1,0]
    v_pk_mul_f32 v[200:201], v[200:201], v[226:227] op_sel_hi:[1,0]
    v_pk_mul_f32 v[202:203], v[202:203], v[226:227] op_sel_hi:[1,0]
    v_pk_mul_f32 v[204:205], v[204:205], v[226:227] op_sel_hi:[1,0]
    v_pk_mul_f32 v[206:207], v[206:207], v[226:227] op_sel_hi:[1,0]
    v_pk_mul_f32 v[208:209], v[208:209], v[226:227] op_sel_hi:[1,0]
    v_pk_mul_f32 v[210:211], v[210:211], v[226:227] op_sel_hi:[1,0]
    v_pk_mul_f32 v[212:213], v[212:213], v[226:227] op_sel_hi:[1,0]
    v_pk_mul_f32 v[214:215], v[214:215], v[226:227] op_sel_hi:[1,0]
    v_pk_mul_f32 v[216:217], v[216:217], v[226:227] op_sel_hi:[1,0]
    v_pk_mul_f32 v[218:219], v[218:219], v[226:227] op_sel_hi:[1,0]
    v_pk_mul_f32 v[220:221], v[220:221], v[226:227] op_sel_hi:[1,0]
    v_pk_mul_f32 v[222:223], v[222:223], v[226:227] op_sel_hi:[1,0]
    v_cvt_pk_bf16_f32 v192, v192, v193
    v_cvt_pk_bf16_f32 v193, v194, v195
    ds_write_b64 v8, v[192:193] offset:13056
    v_cvt_pk_bf16_f32 v196, v196, v197
    v_cvt_pk_bf16_f32 v197, v198, v199
    ds_write_b64 v8, v[196:197] offset:13088
    v_cvt_pk_bf16_f32 v200, v200, v201
    v_cvt_pk_bf16_f32 v201, v202, v203
    ds_write_b64 v8, v[200:201] offset:13120
    v_cvt_pk_bf16_f32 v204, v204, v205
    v_cvt_pk_bf16_f32 v205, v206, v207
    ds_write_b64 v8, v[204:205] offset:13152
    v_cvt_pk_bf16_f32 v208, v208, v209
    v_cvt_pk_bf16_f32 v209, v210, v211
    ds_write_b64 v8, v[208:209] offset:13184
    v_cvt_pk_bf16_f32 v212, v212, v213
    v_cvt_pk_bf16_f32 v213, v214, v215
    ds_write_b64 v8, v[212:213] offset:13216
    v_cvt_pk_bf16_f32 v216, v216, v217
    v_cvt_pk_bf16_f32 v217, v218, v219
    ds_write_b64 v8, v[216:217] offset:13248
    v_cvt_pk_bf16_f32 v220, v220, v221
    v_cvt_pk_bf16_f32 v221, v222, v223
    ds_write_b64 v8, v[220:221] offset:13280
    s_waitcnt lgkmcnt(6)
    s_mov_b32 s41, 18884608
    buffer_store_dwordx4 v[160:163], v0, s[24:27], s41 offen sc0 sc1
    buffer_store_dwordx4 v[164:167], v0, s[24:27], s41 offen offset:1024 sc0 sc1
    buffer_store_dwordx4 v[168:171], v0, s[24:27], s41 offen offset:2048 sc0 sc1
    buffer_store_dwordx4 v[172:175], v0, s[24:27], s41 offen offset:3072 sc0 sc1
    ds_read_b128 v[192:195], v10 offset:15232
    ds_read_b128 v[196:199], v10 offset:16320
    ds_read_b128 v[200:203], v10 offset:17408
    ds_read_b128 v[204:207], v10 offset:18496
    v_cmp_ngt_f32 s[48:49], s44, v14
    s_lshl_b32 s43, s3, 2
    v_mov_b32 v230, 163200
    v_add_u32 v228, s43, v230
    s_cmp_lg_u64 s[48:49], 0
    s_cselect_b32 s43, 1, 0
    v_mov_b32 v229, s43
    ds_write_b32 v228, v229
    s_waitcnt lgkmcnt(4)
    s_mov_b32 s41, 18888704
    buffer_store_dwordx4 v[192:195], v0, s[24:27], s41 offen sc0 sc1
    s_waitcnt lgkmcnt(3)
    buffer_store_dwordx4 v[196:199], v0, s[24:27], s41 offen offset:1024 sc0 sc1
    s_waitcnt lgkmcnt(2)
    buffer_store_dwordx4 v[200:203], v0, s[24:27], s41 offen offset:2048 sc0 sc1
    s_waitcnt lgkmcnt(1)
    buffer_store_dwordx4 v[204:207], v0, s[24:27], s41 offen offset:3072 sc0 sc1
    s_waitcnt lgkmcnt(0)
    s_barrier
    ds_read_b128 v[240:243], v230
    s_waitcnt lgkmcnt(0)
    v_or3_b32 v240, v240, v241, v242
    v_or_b32 v240, v240, v243
    s_nop 0
    v_readfirstlane_b32 s43, v240
    s_cbranch_vccnz L_done1
    s_cmp_lg_u32 s43, 0
    s_cbranch_scc1 L_redo
L_done1:
    s_endpgm
    .p2align 12
L_pa10:
    s_branch L_wa
L_pb10:
    s_branch L_wb2
L_pg10:
L_Cx:
    v_mfma_f32_16x16x32_bf16 v[24:27], a[112:115], a[48:51], v[80:83]
    v_exp_f32 v16, v16
    v_mfma_f32_16x16x32_bf16 v[24:27], a[116:119], a[52:55], v[24:27]
    s_barrier
    v_mfma_f32_16x16x32_bf16 v[24:27], a[120:123], a[56:59], v[24:27]
    v_exp_f32 v17, v17
    v_mfma_f32_16x16x32_bf16 v[24:27], a[124:127], a[60:63], v[24:27]
    v_cvt_pk_bf16_f32 v56, v16, v17
    v_accvgpr_read_b32 v10, a226
    v_mfma_f32_16x16x32_bf16 v[28:31], a[128:131], a[48:51], v[80:83]
    s_lshr_b32 s42, s3, 1
    v_exp_f32 v18, v18
    v_mfma_f32_16x16x32_bf16 v[28:31], a[132:135], a[52:55], v[28:31]
    s_mul_i32 s43, s42, 39168
    v_exp_f32 v19, v19
    v_mfma_f32_16x16x32_bf16 v[28:31], a[136:139], a[56:59], v[28:31]
    v_cvt_pk_bf16_f32 v57, v18, v19
    v_bfe_u32 v50, v0, 7, 3
    v_and_b32 v51, 0x70, v0
    v_mul_u32_u24 v48, 272, v50
    v_mfma_f32_16x16x32_bf16 v[28:31], a[140:143], a[60:63], v[28:31]
    v_exp_f32 v20, v20
    v_mfma_f32_16x16x32_bf16 a[184:187], a[196:199], v[64:67], a[184:187]
    v_exp_f32 v21, v21
    v_mfma_f32_16x16x32_bf16 a[188:191], a[196:199], v[68:71], a[188:191]
    v_cvt_pk_bf16_f32 v58, v20, v21
    v_lshl_add_u32 v49, v50, 8, v51
    v_mfma_f32_16x16x32_bf16 v[160:163], a[144:147], v[64:67], v[160:163]
    v_exp_f32 v22, v22
    v_mfma_f32_16x16x32_bf16 v[192:195], a[144:147], v[68:71], v[192:195]
    v_exp_f32 v23, v23
    v_mfma_f32_16x16x32_bf16 v[196:199], a[148:151], v[68:71], v[196:199]
    ds_read_b64_tr_b16 a[144:145], v5 offset:2048
    v_cvt_pk_bf16_f32 v59, v22, v23
    v_mfma_f32_16x16x32_bf16 v[164:167], a[148:151], v[64:67], v[164:167]
    v_exp_f32 v24, v24
    v_mfma_f32_16x16x32_bf16 v[168:171], a[152:155], v[64:67], v[168:171]
    v_exp_f32 v25, v25
    v_mfma_f32_16x16x32_bf16 v[200:203], a[152:155], v[68:71], v[200:203]
    ds_read_b64_tr_b16 a[146:147], v5 offset:3072
    v_cvt_pk_bf16_f32 v60, v24, v25
    v_mfma_f32_16x16x32_bf16 v[204:207], a[156:159], v[68:71], v[204:207]
    v_exp_f32 v26, v26
    v_mfma_f32_16x16x32_bf16 v[172:175], a[156:159], v[64:67], v[172:175]
    v_exp_f32 v27, v27
    v_mfma_f32_16x16x32_bf16 v[176:179], a[160:163], v[64:67], v[176:179]
    ds_read_b64_tr_b16 a[148:149], v5 offset:2080
    v_cvt_pk_bf16_f32 v61, v26, v27
    v_mfma_f32_16x16x32_bf16 v[208:211], a[160:163], v[68:71], v[208:211]
    v_exp_f32 v28, v28
    v_mfma_f32_16x16x32_bf16 v[212:215], a[164:167], v[68:71], v[212:215]
    v_exp_f32 v29, v29
    v_mfma_f32_16x16x32_bf16 v[180:183], a[164:167], v[64:67], v[180:183]
    ds_read_b64_tr_b16 a[150:151], v5 offset:3104
    v_cvt_pk_bf16_f32 v62, v28, v29
    v_mfma_f32_16x16x32_bf16 v[184:187], a[168:171], v[64:67], v[184:187]
    v_exp_f32 v30, v30
    v_mfma_f32_16x16x32_bf16 v[216:219], a[168:171], v[68:71], v[216:219]
    v_exp_f32 v31, v31
    v_mfma_f32_16x16x32_bf16 v[220:223], a[172:175], v[68:71], v[220:223]
    ds_read_b64_tr_b16 a[152:153], v5 offset:2304
    v_cvt_pk_bf16_f32 v63, v30, v31
    v_mfma_f32_16x16x32_bf16 v[188:191], a[172:175], v[64:67], v[188:191]
    ds_read_b64_tr_b16 a[154:155], v5 offset:3328
    ds_read_b64_tr_b16 a[156:157], v5 offset:2336
    v_mfma_f32_16x16x32_bf16 v[32:35], a[112:115], a[64:67], v[84:87]
    ds_read_b64_tr_b16 a[158:159], v5 offset:3360
    ds_read_b64_tr_b16 a[160:161], v5 offset:2560
    v_mfma_f32_16x16x32_bf16 v[32:35], a[116:119], a[68:71], v[32:35]
    ds_read_b64_tr_b16 a[162:163], v5 offset:3584
    ds_read_b64_tr_b16 a[164:165], v5 offset:2592
    v_mfma_f32_16x16x32_bf16 v[32:35], a[120:123], a[72:75], v[32:35]
    ds_read_b64_tr_b16 a[166:167], v5 offset:3616
    ds_read_b64_tr_b16 a[168:169], v5 offset:2816
    v_mfma_f32_16x16x32_bf16 v[32:35], a[124:127], a[76:79], v[32:35]
    ds_write_b128 v12, a[16:19] offset:4128
    v_mfma_f32_16x16x32_bf16 v[36:39], a[128:131], a[64:67], v[84:87]
    ds_write_b128 v12, a[20:23] offset:5152
    v_mfma_f32_16x16x32_bf16 v[36:39], a[132:135], a[68:71], v[36:39]
    ds_write_b128 v12, a[24:27] offset:6176
    v_mfma_f32_16x16x32_bf16 v[36:39], a[136:139], a[72:75], v[36:39]
    ds_write_b128 v12, a[28:31] offset:7200
    v_mfma_f32_16x16x32_bf16 v[36:39], a[140:143], a[76:79], v[36:39]
    ds_write_b32 v13, a192 offset:64
    v_mfma_f32_16x16x32_bf16 v[40:43], a[112:115], a[80:83], v[88:91]
    v_exp_f32 v32, v32
    v_mfma_f32_16x16x32_bf16 v[40:43], a[116:119], a[84:87], v[40:43]
    v_exp_f32 v33, v33
    v_mfma_f32_16x16x32_bf16 v[40:43], a[120:123], a[88:91], v[40:43]
    ds_read_b64_tr_b16 a[170:171], v5 offset:3840
    v_cvt_pk_bf16_f32 v64, v32, v33
    v_mfma_f32_16x16x32_bf16 v[40:43], a[124:127], a[92:95], v[40:43]
    v_exp_f32 v34, v34
    v_mfma_f32_16x16x32_bf16 v[44:47], a[128:131], a[80:83], v[88:91]
    v_exp_f32 v35, v35
    v_mfma_f32_16x16x32_bf16 v[44:47], a[132:135], a[84:87], v[44:47]
    ds_read_b64_tr_b16 a[172:173], v5 offset:2848
    v_cvt_pk_bf16_f32 v65, v34, v35
    v_mfma_f32_16x16x32_bf16 v[44:47], a[136:139], a[88:91], v[44:47]
    v_exp_f32 v36, v36
    v_mfma_f32_16x16x32_bf16 v[44:47], a[140:143], a[92:95], v[44:47]
    v_exp_f32 v37, v37
    v_mfma_f32_16x16x32_bf16 a[176:179], a[196:199], v[56:59], a[176:179]
    s_waitcnt lgkmcnt(2)
    ds_read_b64_tr_b16 a[174:175], v5 offset:3872
    v_cvt_pk_bf16_f32 v66, v36, v37
    v_mfma_f32_16x16x32_bf16 v[96:99], a[144:147], v[56:59], v[96:99]
    v_exp_f32 v38, v38
    v_mfma_f32_16x16x32_bf16 v[100:103], a[148:151], v[56:59], v[100:103]
    v_exp_f32 v39, v39
    v_mfma_f32_16x16x32_bf16 v[104:107], a[152:155], v[56:59], v[104:107]
    v_cvt_pk_bf16_f32 v67, v38, v39
    v_add3_u32 v48, v48, v51, s43
    v_mfma_f32_16x16x32_bf16 v[108:111], a[156:159], v[56:59], v[108:111]
    v_exp_f32 v40, v40
    v_mfma_f32_16x16x32_bf16 v[112:115], a[160:163], v[56:59], v[112:115]
    v_exp_f32 v41, v41
    v_mfma_f32_16x16x32_bf16 v[116:119], a[164:167], v[56:59], v[116:119]
    s_waitcnt lgkmcnt(1)
    v_cvt_pk_bf16_f32 v68, v40, v41
    v_add_u32 v48, 99968, v48
    v_accvgpr_read_b32 v225, a176
    v_mfma_f32_16x16x32_bf16 v[120:123], a[168:171], v[56:59], v[120:123]
    s_waitcnt lgkmcnt(0)
    s_mul_i32 s42, s42, 36864
    v_exp_f32 v42, v42
    v_mfma_f32_16x16x32_bf16 v[124:127], a[172:175], v[56:59], v[124:127]
    s_add_u32 s42, s42, 18890752
    v_exp_f32 v43, v43
    v_mfma_f32_16x16x32_bf16 a[180:183], a[196:199], v[60:63], a[180:183]
    v_cvt_pk_bf16_f32 v69, v42, v43
    v_rcp_f32 v224, v225
    v_mfma_f32_16x16x32_bf16 v[128:131], a[144:147], v[60:63], v[128:131]
    v_exp_f32 v44, v44
    v_mfma_f32_16x16x32_bf16 v[132:135], a[148:151], v[60:63], v[132:135]
    v_exp_f32 v45, v45
    v_mfma_f32_16x16x32_bf16 v[136:139], a[152:155], v[60:63], v[136:139]
    v_cvt_pk_bf16_f32 v70, v44, v45
    v_add_f32 v14, v14, v225
    v_mfma_f32_16x16x32_bf16 v[140:143], a[156:159], v[60:63], v[140:143]
    s_barrier
    v_pk_mul_f32 v[96:97], v[96:97], v[224:225] op_sel_hi:[1,0]
    v_pk_mul_f32 v[98:99], v[98:99], v[224:225] op_sel_hi:[1,0]
    v_pk_mul_f32 v[100:101], v[100:101], v[224:225] op_sel_hi:[1,0]
    v_pk_mul_f32 v[102:103], v[102:103], v[224:225] op_sel_hi:[1,0]
    v_pk_mul_f32 v[104:105], v[104:105], v[224:225] op_sel_hi:[1,0]
    v_pk_mul_f32 v[106:107], v[106:107], v[224:225] op_sel_hi:[1,0]
    v_pk_mul_f32 v[108:109], v[108:109], v[224:225] op_sel_hi:[1,0]
    v_pk_mul_f32 v[110:111], v[110:111], v[224:225] op_sel_hi:[1,0]
    v_pk_mul_f32 v[112:113], v[112:113], v[224:225] op_sel_hi:[1,0]
    v_pk_mul_f32 v[114:115], v[114:115], v[224:225] op_sel_hi:[1,0]
    v_pk_mul_f32 v[116:117], v[116:117], v[224:225] op_sel_hi:[1,0]
    v_pk_mul_f32 v[118:119], v[118:119], v[224:225] op_sel_hi:[1,0]
    v_pk_mul_f32 v[120:121], v[120:121], v[224:225] op_sel_hi:[1,0]
    v_pk_mul_f32 v[122:123], v[122:123], v[224:225] op_sel_hi:[1,0]
    v_pk_mul_f32 v[124:125], v[124:125], v[224:225] op_sel_hi:[1,0]
    v_pk_mul_f32 v[126:127], v[126:127], v[224:225] op_sel_hi:[1,0]
    v_cvt_pk_bf16_f32 v96, v96, v97
    v_cvt_pk_bf16_f32 v97, v98, v99
    v_mfma_f32_16x16x32_bf16 v[144:147], a[160:163], v[60:63], v[144:147]
    ds_read_b128 v[240:243], v12 offset:0
    ds_read_b128 v[244:247], v12 offset:1024
    v_exp_f32 v46, v46
    v_mfma_f32_16x16x32_bf16 v[148:151], a[164:167], v[60:63], v[148:151]
    v_exp_f32 v47, v47
    v_mfma_f32_16x16x32_bf16 v[152:155], a[168:171], v[60:63], v[152:155]
    ds_read_b128 v[248:251], v12 offset:2048
    v_cvt_pk_bf16_f32 v71, v46, v47
    v_mfma_f32_16x16x32_bf16 v[156:159], a[172:175], v[60:63], v[156:159]
    ds_read_b128 v[252:255], v12 offset:3072
    ds_read_b32 v232, v13 offset:0
    v_mfma_f32_16x16x32_bf16 a[184:187], a[196:199], v[64:67], a[184:187]
    ds_write_b64 v8, v[96:97] offset:0
    v_mfma_f32_16x16x32_bf16 v[160:163], a[144:147], v[64:67], v[160:163]
    v_cvt_pk_bf16_f32 v100, v100, v101
    v_cvt_pk_bf16_f32 v101, v102, v103
    v_mfma_f32_16x16x32_bf16 v[164:167], a[148:151], v[64:67], v[164:167]
    ds_write_b64 v8, v[100:101] offset:32
    v_mfma_f32_16x16x32_bf16 v[168:171], a[152:155], v[64:67], v[168:171]
    v_cvt_pk_bf16_f32 v104, v104, v105
    v_cvt_pk_bf16_f32 v105, v106, v107
    v_mfma_f32_16x16x32_bf16 v[172:175], a[156:159], v[64:67], v[172:175]
    ds_write_b64 v8, v[104:105] offset:64
    v_mfma_f32_16x16x32_bf16 v[176:179], a[160:163], v[64:67], v[176:179]
    v_cvt_pk_bf16_f32 v108, v108, v109
    v_cvt_pk_bf16_f32 v109, v110, v111
    v_mfma_f32_16x16x32_bf16 v[180:183], a[164:167], v[64:67], v[180:183]
    ds_write_b64 v8, v[108:109] offset:96
    v_mfma_f32_16x16x32_bf16 v[184:187], a[168:171], v[64:67], v[184:187]
    v_cvt_pk_bf16_f32 v112, v112, v113
    v_cvt_pk_bf16_f32 v113, v114, v115
    v_mfma_f32_16x16x32_bf16 v[188:191], a[172:175], v[64:67], v[188:191]
    ds_write_b64 v8, v[112:113] offset:128
    v_mfma_f32_16x16x32_bf16 a[188:191], a[196:199], v[68:71], a[188:191]
    v_cvt_pk_bf16_f32 v116, v116, v117
    v_cvt_pk_bf16_f32 v117, v118, v119
    v_mfma_f32_16x16x32_bf16 v[192:195], a[144:147], v[68:71], v[192:195]
    ds_write_b64 v8, v[116:117] offset:160
    v_mfma_f32_16x16x32_bf16 v[196:199], a[148:151], v[68:71], v[196:199]
    v_cvt_pk_bf16_f32 v120, v120, v121
    v_cvt_pk_bf16_f32 v121, v122, v123
    v_mfma_f32_16x16x32_bf16 v[200:203], a[152:155], v[68:71], v[200:203]
    ds_write_b64 v8, v[120:121] offset:192
    v_mfma_f32_16x16x32_bf16 v[204:207], a[156:159], v[68:71], v[204:207]
    v_cvt_pk_bf16_f32 v124, v124, v125
    v_cvt_pk_bf16_f32 v125, v126, v127
    v_mfma_f32_16x16x32_bf16 v[208:211], a[160:163], v[68:71], v[208:211]
    ds_write_b64 v8, v[124:125] offset:224
    ds_read_b128 v[96:99], v10 offset:0
    v_mfma_f32_16x16x32_bf16 v[212:215], a[164:167], v[68:71], v[212:215]
    ds_read_b128 v[100:103], v10 offset:1088
    ds_read_b128 v[104:107], v10 offset:2176
    v_mfma_f32_16x16x32_bf16 v[216:219], a[168:171], v[68:71], v[216:219]
    ds_read_b128 v[108:111], v10 offset:3264
    v_accvgpr_read_b32 v233, a192
    v_mfma_f32_16x16x32_bf16 v[220:223], a[172:175], v[68:71], v[220:223]
    s_waitcnt lgkmcnt(6)
    v_add_f32 v232, v232, v233
    v_rcp_f32 v234, v232
    v_add_f32 v14, v14, v232
    v_accvgpr_read_b32 v228, a0
    v_accvgpr_read_b32 v229, a1
    v_accvgpr_read_b32 v230, a2
    v_accvgpr_read_b32 v231, a3
    v_pk_add_f32 v[240:241], v[240:241], v[228:229]
    v_pk_add_f32 v[242:243], v[242:243], v[230:231]
    v_pk_mul_f32 v[240:241], v[240:241], v[234:235] op_sel_hi:[1,0]
    v_pk_mul_f32 v[242:243], v[242:243], v[234:235] op_sel_hi:[1,0]
    v_cvt_pk_bf16_f32 v240, v240, v241
    v_cvt_pk_bf16_f32 v241, v242, v243
    ds_write_b64 v9, v[240:241] offset:0
    v_accvgpr_read_b32 v228, a4
    v_accvgpr_read_b32 v229, a5
    v_accvgpr_read_b32 v230, a6
    v_accvgpr_read_b32 v231, a7
    v_pk_add_f32 v[244:245], v[244:245], v[228:229]
    v_pk_add_f32 v[246:247], v[246:247], v[230:231]
    v_pk_mul_f32 v[244:245], v[244:245], v[234:235] op_sel_hi:[1,0]
    v_pk_mul_f32 v[246:247], v[246:247], v[234:235] op_sel_hi:[1,0]
    v_cvt_pk_bf16_f32 v244, v244, v245
    v_cvt_pk_bf16_f32 v245, v246, v247
    ds_write_b64 v9, v[244:245] offset:32
    v_accvgpr_read_b32 v228, a8
    v_accvgpr_read_b32 v229, a9
    v_accvgpr_read_b32 v230, a10
    v_accvgpr_read_b32 v231, a11
    v_pk_add_f32 v[248:249], v[248:249], v[228:229]
    v_pk_add_f32 v[250:251], v[250:251], v[230:231]
    v_pk_mul_f32 v[248:249], v[248:249], v[234:235] op_sel_hi:[1,0]
    v_pk_mul_f32 v[250:251], v[250:251], v[234:235] op_sel_hi:[1,0]
    v_cvt_pk_bf16_f32 v248, v248, v249
    v_cvt_pk_bf16_f32 v249, v250, v251
    ds_write_b64 v9, v[248:249] offset:64
    v_accvgpr_read_b32 v228, a12
    v_accvgpr_read_b32 v229, a13
    v_accvgpr_read_b32 v230, a14
    v_accvgpr_read_b32 v231, a15
    v_pk_add_f32 v[252:253], v[252:253], v[228:229]
    v_pk_add_f32 v[254:255], v[254:255], v[230:231]
    v_pk_mul_f32 v[252:253], v[252:253], v[234:235] op_sel_hi:[1,0]
    v_pk_mul_f32 v[254:255], v[254:255], v[234:235] op_sel_hi:[1,0]
    v_cvt_pk_bf16_f32 v252, v252, v253
    v_cvt_pk_bf16_f32 v253, v254, v255
    ds_write_b64 v9, v[252:253] offset:96
    s_waitcnt lgkmcnt(4)
    s_mov_b32 s41, 18874368
    buffer_store_dwordx4 v[96:99], v0, s[24:27], s41 offen sc0 sc1
    buffer_store_dwordx4 v[100:103], v0, s[24:27], s41 offen offset:1024 sc0 sc1
    buffer_store_dwordx4 v[104:107], v0, s[24:27], s41 offen offset:2048 sc0 sc1
    buffer_store_dwordx4 v[108:111], v0, s[24:27], s41 offen offset:3072 sc0 sc1
    ds_read_b128 v[240:243], v48 offset:0
    ds_read_b128 v[244:247], v48 offset:2176
    v_accvgpr_read_b32 v227, a180
    v_rcp_f32 v226, v227
    v_add_f32 v14, v14, v227
    v_pk_mul_f32 v[128:129], v[128:129], v[226:227] op_sel_hi:[1,0]
    v_pk_mul_f32 v[130:131], v[130:131], v[226:227] op_sel_hi:[1,0]
    v_pk_mul_f32 v[132:133], v[132:133], v[226:227] op_sel_hi:[1,0]
    v_pk_mul_f32 v[134:135], v[134:135], v[226:227] op_sel_hi:[1,0]
    v_pk_mul_f32 v[136:137], v[136:137], v[226:227] op_sel_hi:[1,0]
    v_pk_mul_f32 v[138:139], v[138:139], v[226:227] op_sel_hi:[1,0]
    v_pk_mul_f32 v[140:141], v[140:141], v[226:227] op_sel_hi:[1,0]
    v_pk_mul_f32 v[142:143], v[142:143], v[226:227] op_sel_hi:[1,0]
    v_pk_mul_f32 v[144:145], v[144:145], v[226:227] op_sel_hi:[1,0]
    v_pk_mul_f32 v[146:147], v[146:147], v[226:227] op_sel_hi:[1,0]
    v_pk_mul_f32 v[148:149], v[148:149], v[226:227] op_sel_hi:[1,0]
    v_pk_mul_f32 v[150:151], v[150:151], v[226:227] op_sel_hi:[1,0]
    v_pk_mul_f32 v[152:153], v[152:153], v[226:227] op_sel_hi:[1,0]
    v_pk_mul_f32 v[154:155], v[154:155], v[226:227] op_sel_hi:[1,0]
    v_pk_mul_f32 v[156:157], v[156:157], v[226:227] op_sel_hi:[1,0]
    v_pk_mul_f32 v[158:159], v[158:159], v[226:227] op_sel_hi:[1,0]
    v_cvt_pk_bf16_f32 v128, v128, v129
    v_cvt_pk_bf16_f32 v129, v130, v131
    ds_write_b64 v8, v[128:129] offset:4352
    v_cvt_pk_bf16_f32 v132, v132, v133
    v_cvt_pk_bf16_f32 v133, v134, v135
    ds_write_b64 v8, v[132:133] offset:4384
    v_cvt_pk_bf16_f32 v136, v136, v137
    v_cvt_pk_bf16_f32 v137, v138, v139
    ds_write_b64 v8, v[136:137] offset:4416
    v_cvt_pk_bf16_f32 v140, v140, v141
    v_cvt_pk_bf16_f32 v141, v142, v143
    ds_write_b64 v8, v[140:141] offset:4448
    v_cvt_pk_bf16_f32 v144, v144, v145
    v_cvt_pk_bf16_f32 v145, v146, v147
    ds_write_b64 v8, v[144:145] offset:4480
    v_cvt_pk_bf16_f32 v148, v148, v149
    v_cvt_pk_bf16_f32 v149, v150, v151
    ds_write_b64 v8, v[148:149] offset:4512
    v_cvt_pk_bf16_f32 v152, v152, v153
    v_cvt_pk_bf16_f32 v153, v154, v155
    ds_write_b64 v8, v[152:153] offset:4544
    v_cvt_pk_bf16_f32 v156, v156, v157
    v_cvt_pk_bf16_f32 v157, v158, v159
    ds_write_b64 v8, v[156:157] offset:4576
    s_waitcnt lgkmcnt(6)
    buffer_store_dwordx4 v[240:243], v49, s[24:27], s42 offen sc0 sc1
    buffer_store_dwordx4 v[244:247], v49, s[24:27], s42 offen offset:2048 sc0 sc1
    ds_read_b128 v[128:131], v10 offset:4352
    ds_read_b128 v[132:135], v10 offset:5440
    ds_read_b128 v[136:139], v10 offset:6528
    ds_read_b128 v[140:143], v10 offset:7616
    v_accvgpr_read_b32 v225, a184
    v_rcp_f32 v224, v225
    v_add_f32 v14, v14, v225
    v_pk_mul_f32 v[160:161], v[160:161], v[224:225] op_sel_hi:[1,0]
    v_pk_mul_f32 v[162:163], v[162:163], v[224:225] op_sel_hi:[1,0]
    v_pk_mul_f32 v[164:165], v[164:165], v[224:225] op_sel_hi:[1,0]
    v_pk_mul_f32 v[166:167], v[166:167], v[224:225] op_sel_hi:[1,0]
    v_pk_mul_f32 v[168:169], v[168:169], v[224:225] op_sel_hi:[1,0]
    v_pk_mul_f32 v[170:171], v[170:171], v[224:225] op_sel_hi:[1,0]
    v_pk_mul_f32 v[172:173], v[172:173], v[224:225] op_sel_hi:[1,0]
    v_pk_mul_f32 v[174:175], v[174:175], v[224:225] op_sel_hi:[1,0]
    v_pk_mul_f32 v[176:177], v[176:177], v[224:225] op_sel_hi:[1,0]
    v_pk_mul_f32 v[178:179], v[178:179], v[224:225] op_sel_hi:[1,0]
    v_pk_mul_f32 v[180:181], v[180:181], v[224:225] op_sel_hi:[1,0]
    v_pk_mul_f32 v[182:183], v[182:183], v[224:225] op_sel_hi:[1,0]
    v_pk_mul_f32 v[184:185], v[184:185], v[224:225] op_sel_hi:[1,0]
    v_pk_mul_f32 v[186:187], v[186:187], v[224:225] op_sel_hi:[1,0]
    v_pk_mul_f32 v[188:189], v[188:189], v[224:225] op_sel_hi:[1,0]
    v_pk_mul_f32 v[190:191], v[190:191], v[224:225] op_sel_hi:[1,0]
    v_cvt_pk_bf16_f32 v160, v160, v161
    v_cvt_pk_bf16_f32 v161, v162, v163
    ds_write_b64 v8, v[160:161] offset:8704
    v_cvt_pk_bf16_f32 v164, v164, v165
    v_cvt_pk_bf16_f32 v165, v166, v167
    ds_write_b64 v8, v[164:165] offset:8736
    v_cvt_pk_bf16_f32 v168, v168, v169
    v_cvt_pk_bf16_f32 v169, v170, v171
    ds_write_b64 v8, v[168:169] offset:8768
    v_cvt_pk_bf16_f32 v172, v172, v173
    v_cvt_pk_bf16_f32 v173, v174, v175
    ds_write_b64 v8, v[172:173] offset:8800
    v_cvt_pk_bf16_f32 v176, v176, v177
    v_cvt_pk_bf16_f32 v177, v178, v179
    ds_write_b64 v8, v[176:177] offset:8832
    v_cvt_pk_bf16_f32 v180, v180, v181
    v_cvt_pk_bf16_f32 v181, v182, v183
    ds_write_b64 v8, v[180:181] offset:8864
    v_cvt_pk_bf16_f32 v184, v184, v185
    v_cvt_pk_bf16_f32 v185, v186, v187
    ds_write_b64 v8, v[184:185] offset:8896
    v_cvt_pk_bf16_f32 v188, v188, v189
    v_cvt_pk_bf16_f32 v189, v190, v191
    ds_write_b64 v8, v[188:189] offset:8928
    s_waitcnt lgkmcnt(6)
    s_mov_b32 s41, 18878464
    buffer_store_dwordx4 v[128:131], v0, s[24:27], s41 offen sc0 sc1
    buffer_store_dwordx4 v[132:135], v0, s[24:27], s41 offen offset:1024 sc0 sc1
    buffer_store_dwordx4 v[136:139], v0, s[24:27], s41 offen offset:2048 sc0 sc1
    buffer_store_dwordx4 v[140:143], v0, s[24:27], s41 offen offset:3072 sc0 sc1
    ds_read_b128 v[160:163], v10 offset:8704
    ds_read_b128 v[164:167], v10 offset:9792
    ds_read_b128 v[168:171], v10 offset:10880
    ds_read_b128 v[172:175], v10 offset:11968
    v_accvgpr_read_b32 v227, a188
    v_rcp_f32 v226, v227
    v_add_f32 v14, v14, v227
    v_pk_mul_f32 v[192:193], v[192:193], v[226:227] op_sel_hi:[1,0]
    v_pk_mul_f32 v[194:195], v[194:195], v[226:227] op_sel_hi:[1,0]
    v_pk_mul_f32 v[196:197], v[196:197], v[226:227] op_sel_hi:[1,0]
    v_pk_mul_f32 v[198:199], v[198:199], v[226:227] op_sel_hi:[1,0]
    v_pk_mul_f32 v[200:201], v[200:201], v[226:227] op_sel_hi:[1,0]
    v_pk_mul_f32 v[202:203], v[202:203], v[226:227] op_sel_hi:[1,0]
    v_pk_mul_f32 v[204:205], v[204:205], v[226:227] op_sel_hi:[1,0]
    v_pk_mul_f32 v[206:207], v[206:207], v[226:227] op_sel_hi:[1,0]
    v_pk_mul_f32 v[208:209], v[208:209], v[226:227] op_sel_hi:[1,0]
    v_pk_mul_f32 v[210:211], v[210:211], v[226:227] op_sel_hi:[1,0]
    v_pk_mul_f32 v[212:213], v[212:213], v[226:227] op_sel_hi:[1,0]
    v_pk_mul_f32 v[214:215], v[214:215], v[226:227] op_sel_hi:[1,0]
    v_pk_mul_f32 v[216:217], v[216:217], v[226:227] op_sel_hi:[1,0]
    v_pk_mul_f32 v[218:219], v[218:219], v[226:227] op_sel_hi:[1,0]
    v_pk_mul_f32 v[220:221], v[220:221], v[226:227] op_sel_hi:[1,0]
    v_pk_mul_f32 v[222:223], v[222:223], v[226:227] op_sel_hi:[1,0]
    v_cvt_pk_bf16_f32 v192, v192, v193
    v_cvt_pk_bf16_f32 v193, v194, v195
    ds_write_b64 v8, v[192:193] offset:13056
    v_cvt_pk_bf16_f32 v196, v196, v197
    v_cvt_pk_bf16_f32 v197, v198, v199
    ds_write_b64 v8, v[196:197] offset:13088
    v_cvt_pk_bf16_f32 v200, v200, v201
    v_cvt_pk_bf16_f32 v201, v202, v203
    ds_write_b64 v8, v[200:201] offset:13120
    v_cvt_pk_bf16_f32 v204, v204, v205
    v_cvt_pk_bf16_f32 v205, v206, v207
    ds_write_b64 v8, v[204:205] offset:13152
    v_cvt_pk_bf16_f32 v208, v208, v209
    v_cvt_pk_bf16_f32 v209, v210, v211
    ds_write_b64 v8, v[208:209] offset:13184
    v_cvt_pk_bf16_f32 v212, v212, v213
    v_cvt_pk_bf16_f32 v213, v214, v215
    ds_write_b64 v8, v[212:213] offset:13216
    v_cvt_pk_bf16_f32 v216, v216, v217
    v_cvt_pk_bf16_f32 v217, v218, v219
    ds_write_b64 v8, v[216:217] offset:13248
    v_cvt_pk_bf16_f32 v220, v220, v221
    v_cvt_pk_bf16_f32 v221, v222, v223
    ds_write_b64 v8, v[220:221] offset:13280
    s_waitcnt lgkmcnt(6)
    s_mov_b32 s41, 18882560
    buffer_store_dwordx4 v[160:163], v0, s[24:27], s41 offen sc0 sc1
    buffer_store_dwordx4 v[164:167], v0, s[24:27], s41 offen offset:1024 sc0 sc1
    buffer_store_dwordx4 v[168:171], v0, s[24:27], s41 offen offset:2048 sc0 sc1
    buffer_store_dwordx4 v[172:175], v0, s[24:27], s41 offen offset:3072 sc0 sc1
    ds_read_b128 v[192:195], v10 offset:13056
    ds_read_b128 v[196:199], v10 offset:14144
    ds_read_b128 v[200:203], v10 offset:15232
    ds_read_b128 v[204:207], v10 offset:16320
    v_cmp_ngt_f32 s[48:49], s44, v14
    s_lshl_b32 s43, s3, 2
    v_mov_b32 v230, 163200
    v_add_u32 v228, s43, v230
    s_cmp_lg_u64 s[48:49], 0
    s_cselect_b32 s43, 1, 0
    v_mov_b32 v229, s43
    ds_write_b32 v228, v229
    s_waitcnt lgkmcnt(4)
    s_mov_b32 s41, 18886656
    buffer_store_dwordx4 v[192:195], v0, s[24:27], s41 offen sc0 sc1
    s_waitcnt lgkmcnt(3)
    buffer_store_dwordx4 v[196:199], v0, s[24:27], s41 offen offset:1024 sc0 sc1
    s_waitcnt lgkmcnt(2)
    buffer_store_dwordx4 v[200:203], v0, s[24:27], s41 offen offset:2048 sc0 sc1
    s_waitcnt lgkmcnt(1)
    buffer_store_dwordx4 v[204:207], v0, s[24:27], s41 offen offset:3072 sc0 sc1
    s_waitcnt lgkmcnt(0)
    s_barrier
    ds_read_b128 v[240:243], v230
    s_waitcnt lgkmcnt(0)
    v_or3_b32 v240, v240, v241, v242
    v_or_b32 v240, v240, v243
    s_nop 0
    v_readfirstlane_b32 s43, v240
    s_cbranch_vccnz L_done0
    s_cmp_lg_u32 s43, 0
    s_cbranch_scc1 L_redo
L_done0:
    s_endpgm
L_fix0a0:
    v_accvgpr_read_b32 v76, a221
    v_accvgpr_read_b32 v77, a221
    v_accvgpr_read_b32 v78, a221
    v_accvgpr_read_b32 v79, a221
    s_nop 1
    s_branch L_fix0a0r
L_fix0a1:
    v_accvgpr_read_b32 v80, a222
    v_accvgpr_read_b32 v81, a222
    v_accvgpr_read_b32 v82, a222
    v_accvgpr_read_b32 v83, a222
    s_nop 1
    s_branch L_fix0a1r
L_fix0c:
    v_accvgpr_read_b32 v92, a225
    v_accvgpr_read_b32 v93, a225
    v_accvgpr_read_b32 v94, a225
    v_accvgpr_read_b32 v95, a225
    s_nop 1
    s_branch L_fix0cr
L_fix0b0:
    v_accvgpr_read_b32 v84, a223
    v_accvgpr_read_b32 v85, a223
    v_accvgpr_read_b32 v86, a223
    v_accvgpr_read_b32 v87, a223
    s_nop 1
    s_branch L_fix0b0r
L_fix0b1:
    v_accvgpr_read_b32 v88, a224
    v_accvgpr_read_b32 v89, a224
    v_accvgpr_read_b32 v90, a224
    v_accvgpr_read_b32 v91, a224
    s_nop 1
    s_branch L_fix0b1r
L_fix1a0:
    v_accvgpr_read_b32 v76, a221
    v_accvgpr_read_b32 v77, a221
    v_accvgpr_read_b32 v78, a221
    v_accvgpr_read_b32 v79, a221
    s_nop 1
    s_branch L_fix1a0r
L_fix1a1:
    v_accvgpr_read_b32 v80, a222
    v_accvgpr_read_b32 v81, a222
    v_accvgpr_read_b32 v82, a222
    v_accvgpr_read_b32 v83, a222
    s_nop 1
    s_branch L_fix1a1r
L_fix1c:
    v_accvgpr_read_b32 v92, a225
    v_accvgpr_read_b32 v93, a225
    v_accvgpr_read_b32 v94, a225
    v_accvgpr_read_b32 v95, a225
    s_nop 1
    s_branch L_fix1cr
L_fix1b0:
    v_accvgpr_read_b32 v84, a223
    v_accvgpr_read_b32 v85, a223
    v_accvgpr_read_b32 v86, a223
    v_accvgpr_read_b32 v87, a223
    s_nop 1
    s_branch L_fix1b0r
L_fix1b1:
    v_accvgpr_read_b32 v88, a224
    v_accvgpr_read_b32 v89, a224
    v_accvgpr_read_b32 v90, a224
    v_accvgpr_read_b32 v91, a224
    s_nop 1
    s_branch L_fix1b1r
L_prepass_ret:
    ds_read_b128 a[112:115], v4 offset:0
    ds_read_b128 a[116:119], v4 offset:256
    ds_read_b128 a[120:123], v4 offset:512
    ds_read_b128 a[124:127], v4 offset:768
    ds_read_b128 a[128:131], v4 offset:1024
    ds_read_b128 a[132:135], v4 offset:1280
    ds_read_b128 a[136:139], v4 offset:1536
    ds_read_b128 a[140:143], v4 offset:1792
    v_accvgpr_read_b32 v76, a216
    v_accvgpr_read_b32 v77, a216
    v_accvgpr_read_b32 v78, a216
    v_accvgpr_read_b32 v79, a216
    v_accvgpr_read_b32 v80, a217
    v_accvgpr_read_b32 v81, a217
    v_accvgpr_read_b32 v82, a217
    v_accvgpr_read_b32 v83, a217
    v_accvgpr_read_b32 v84, a218
    v_accvgpr_read_b32 v85, a218
    v_accvgpr_read_b32 v86, a218
    v_accvgpr_read_b32 v87, a218
    v_accvgpr_read_b32 v88, a219
    v_accvgpr_read_b32 v89, a219
    v_accvgpr_read_b32 v90, a219
    v_accvgpr_read_b32 v91, a219
    v_accvgpr_read_b32 v92, a220
    v_accvgpr_read_b32 v93, a220
    v_accvgpr_read_b32 v94, a220
    v_accvgpr_read_b32 v95, a220
    s_waitcnt lgkmcnt(0)
    v_mfma_f32_16x16x32_bf16 v[16:19], a[112:115], a[32:35], v[76:79]
    v_mfma_f32_16x16x32_bf16 v[16:19], a[116:119], a[36:39], v[16:19]
    v_mfma_f32_16x16x32_bf16 v[16:19], a[120:123], a[40:43], v[16:19]
    v_mfma_f32_16x16x32_bf16 v[16:19], a[124:127], a[44:47], v[16:19]
    v_mfma_f32_16x16x32_bf16 v[20:23], a[128:131], a[32:35], v[76:79]
    v_mfma_f32_16x16x32_bf16 v[20:23], a[132:135], a[36:39], v[20:23]
    v_mfma_f32_16x16x32_bf16 v[20:23], a[136:139], a[40:43], v[20:23]
    v_mfma_f32_16x16x32_bf16 v[20:23], a[140:143], a[44:47], v[20:23]
    s_nop 7
    s_branch L_fix0r
L_prepass:
    v_bfe_u32 v224, v0, 4, 4
    v_lshl_add_u32 v224, v224, 8, v15
    v_add_u32 v225, 4096, v224
    v_mov_b32 v240, 0xff800000
    v_mov_b32 v241, 0xff800000
    v_mov_b32 v242, 0xff800000
    v_mov_b32 v243, 0xff800000
    v_mov_b32 v244, 0xff800000
    s_xor_b32 s41, s34, 0
    s_mul_i32 s41, s41, 33554432
    s_mov_b32 s42, 16
L_prepass_loop:
    buffer_load_dwordx4 a[112:115], v224, s[16:19], s41 offen offset:0
    buffer_load_dwordx4 a[116:119], v224, s[16:19], s41 offen offset:64
    buffer_load_dwordx4 a[120:123], v224, s[16:19], s41 offen offset:128
    buffer_load_dwordx4 a[124:127], v224, s[16:19], s41 offen offset:192
    buffer_load_dwordx4 a[128:131], v225, s[16:19], s41 offen offset:0
    buffer_load_dwordx4 a[132:135], v225, s[16:19], s41 offen offset:64
    buffer_load_dwordx4 a[136:139], v225, s[16:19], s41 offen offset:128
    buffer_load_dwordx4 a[140:143], v225, s[16:19], s41 offen offset:192
    s_waitcnt vmcnt(0) lgkmcnt(0)
    v_mfma_f32_16x16x32_bf16 v[16:19], a[112:115], a[32:35], 0
    v_mfma_f32_16x16x32_bf16 v[16:19], a[116:119], a[36:39], v[16:19]
    v_mfma_f32_16x16x32_bf16 v[16:19], a[120:123], a[40:43], v[16:19]
    v_mfma_f32_16x16x32_bf16 v[16:19], a[124:127], a[44:47], v[16:19]
    v_mfma_f32_16x16x32_bf16 v[20:23], a[128:131], a[32:35], 0
    v_mfma_f32_16x16x32_bf16 v[20:23], a[132:135], a[36:39], v[20:23]
    v_mfma_f32_16x16x32_bf16 v[20:23], a[136:139], a[40:43], v[20:23]
    v_mfma_f32_16x16x32_bf16 v[20:23], a[140:143], a[44:47], v[20:23]
    v_mfma_f32_16x16x32_bf16 v[24:27], a[112:115], a[48:51], 0
    v_mfma_f32_16x16x32_bf16 v[24:27], a[116:119], a[52:55], v[24:27]
    v_mfma_f32_16x16x32_bf16 v[24:27], a[120:123], a[56:59], v[24:27]
    v_mfma_f32_16x16x32_bf16 v[24:27], a[124:127], a[60:63], v[24:27]
    v_mfma_f32_16x16x32_bf16 v[28:31], a[128:131], a[48:51], 0
    v_mfma_f32_16x16x32_bf16 v[28:31], a[132:135], a[52:55], v[28:31]
    v_mfma_f32_16x16x32_bf16 v[28:31], a[136:139], a[56:59], v[28:31]
    v_mfma_f32_16x16x32_bf16 v[28:31], a[140:143], a[60:63], v[28:31]
    v_mfma_f32_16x16x32_bf16 v[32:35], a[112:115], a[64:67], 0
    v_mfma_f32_16x16x32_bf16 v[32:35], a[116:119], a[68:71], v[32:35]
    v_mfma_f32_16x16x32_bf16 v[32:35], a[120:123], a[72:75], v[32:35]
    v_mfma_f32_16x16x32_bf16 v[32:35], a[124:127], a[76:79], v[32:35]
    v_mfma_f32_16x16x32_bf16 v[36:39], a[128:131], a[64:67], 0
    v_mfma_f32_16x16x32_bf16 v[36:39], a[132:135], a[68:71], v[36:39]
    v_mfma_f32_16x16x32_bf16 v[36:39], a[136:139], a[72:75], v[36:39]
    v_mfma_f32_16x16x32_bf16 v[36:39], a[140:143], a[76:79], v[36:39]
    v_mfma_f32_16x16x32_bf16 v[40:43], a[112:115], a[80:83], 0
    v_mfma_f32_16x16x32_bf16 v[40:43], a[116:119], a[84:87], v[40:43]
    v_mfma_f32_16x16x32_bf16 v[40:43], a[120:123], a[88:91], v[40:43]
    v_mfma_f32_16x16x32_bf16 v[40:43], a[124:127], a[92:95], v[40:43]
    v_mfma_f32_16x16x32_bf16 v[44:47], a[128:131], a[80:83], 0
    v_mfma_f32_16x16x32_bf16 v[44:47], a[132:135], a[84:87], v[44:47]
    v_mfma_f32_16x16x32_bf16 v[44:47], a[136:139], a[88:91], v[44:47]
    v_mfma_f32_16x16x32_bf16 v[44:47], a[140:143], a[92:95], v[44:47]
    v_mfma_f32_16x16x32_bf16 v[48:51], a[112:115], a[96:99], 0
    v_mfma_f32_16x16x32_bf16 v[48:51], a[116:119], a[100:103], v[48:51]
    v_mfma_f32_16x16x32_bf16 v[48:51], a[120:123], a[104:107], v[48:51]
    v_mfma_f32_16x16x32_bf16 v[48:51], a[124:127], a[108:111], v[48:51]
    v_mfma_f32_16x16x32_bf16 v[52:55], a[128:131], a[96:99], 0
    v_mfma_f32_16x16x32_bf16 v[52:55], a[132:135], a[100:103], v[52:55]
    v_mfma_f32_16x16x32_bf16 v[52:55], a[136:139], a[104:107], v[52:55]
    v_mfma_f32_16x16x32_bf16 v[52:55], a[140:143], a[108:111], v[52:55]
    v_max3_f32 v240, v240, v16, v17
    v_max3_f32 v240, v240, v18, v19
    v_max3_f32 v240, v240, v20, v21
    v_max3_f32 v240, v240, v22, v23
    v_max3_f32 v241, v241, v24, v25
    v_max3_f32 v241, v241, v26, v27
    v_max3_f32 v241, v241, v28, v29
    v_max3_f32 v241, v241, v30, v31
    v_max3_f32 v242, v242, v32, v33
    v_max3_f32 v242, v242, v34, v35
    v_max3_f32 v242, v242, v36, v37
    v_max3_f32 v242, v242, v38, v39
    v_max3_f32 v243, v243, v40, v41
    v_max3_f32 v243, v243, v42, v43
    v_max3_f32 v243, v243, v44, v45
    v_max3_f32 v243, v243, v46, v47
    v_max3_f32 v244, v244, v48, v49
    v_max3_f32 v244, v244, v50, v51
    v_max3_f32 v244, v244, v52, v53
    v_max3_f32 v244, v244, v54, v55
    s_add_u32 s41, s41, 8192
    s_sub_u32 s42, s42, 1
    s_cmp_lg_u32 s42, 0
    s_cbranch_scc1 L_prepass_loop
    v_mov_b32 v224, v240
    s_nop 1
    v_permlane16_swap_b32 v240, v224
    v_max_f32 v240, v240, v224
    v_mov_b32 v224, v240
    s_nop 1
    v_permlane32_swap_b32 v240, v224
    v_max_f32 v240, v240, v224
    v_sub_f32 v240, 0, v240
    v_accvgpr_read_b32 v224, a216
    v_accvgpr_write_b32 a221, v224
    v_accvgpr_write_b32 a216, v240
    v_mov_b32 v224, v241
    s_nop 1
    v_permlane16_swap_b32 v241, v224
    v_max_f32 v241, v241, v224
    v_mov_b32 v224, v241
    s_nop 1
    v_permlane32_swap_b32 v241, v224
    v_max_f32 v241, v241, v224
    v_sub_f32 v241, 0, v241
    v_accvgpr_read_b32 v224, a217
    v_accvgpr_write_b32 a222, v224
    v_accvgpr_write_b32 a217, v241
    v_mov_b32 v224, v242
    s_nop 1
    v_permlane16_swap_b32 v242, v224
    v_max_f32 v242, v242, v224
    v_mov_b32 v224, v242
    s_nop 1
    v_permlane32_swap_b32 v242, v224
    v_max_f32 v242, v242, v224
    v_sub_f32 v242, 0, v242
    v_accvgpr_read_b32 v224, a218
    v_accvgpr_write_b32 a223, v224
    v_accvgpr_write_b32 a218, v242
    v_mov_b32 v224, v243
    s_nop 1
    v_permlane16_swap_b32 v243, v224
    v_max_f32 v243, v243, v224
    v_mov_b32 v224, v243
    s_nop 1
    v_permlane32_swap_b32 v243, v224
    v_max_f32 v243, v243, v224
    v_sub_f32 v243, 0, v243
    v_accvgpr_read_b32 v224, a219
    v_accvgpr_write_b32 a224, v224
    v_accvgpr_write_b32 a219, v243
    v_mov_b32 v224, v244
    s_nop 1
    v_permlane16_swap_b32 v244, v224
    v_max_f32 v244, v244, v224
    v_mov_b32 v224, v244
    s_nop 1
    v_permlane32_swap_b32 v244, v224
    v_max_f32 v244, v244, v224
    v_sub_f32 v244, 0, v244
    v_accvgpr_read_b32 v224, a220
    v_accvgpr_write_b32 a225, v224
    v_accvgpr_write_b32 a220, v244
    s_cmp_eq_u32 s34, 0
    s_cbranch_scc1 L_prepass_ret
    s_mov_b32 s34, 0
    s_barrier
    s_branch L_start
.section .rodata,"a"
.p2align 6
.amdhsa_kernel standalone__mha_softmax__near_ridge_kernel
  .amdhsa_next_free_vgpr 512
  .amdhsa_next_free_sgpr 102
  .amdhsa_accum_offset 256
  .amdhsa_group_segment_fixed_size 0
  .amdhsa_kernarg_size 48
  .amdhsa_user_sgpr_count 2
  .amdhsa_user_sgpr_kernarg_segment_ptr 1
  .amdhsa_system_sgpr_workgroup_id_x 1
.end_amdhsa_kernel
```
